```python
import torch

def _softmax(x, axis=-1):
    return torch.softmax(x, dim=axis)
def _gelu(x):
    return torch.nn.functional.gelu(x, approximate="tanh")
def _silu(x):
    return torch.nn.functional.silu(x)
def _sigmoid(x):
    return torch.sigmoid(x)
def _layernorm(x, axis=-1, eps=1e-5):
    m = x.mean(dim=axis, keepdim=True)
    v = x.var(dim=axis, keepdim=True, unbiased=False)
    return (x - m) / torch.sqrt(v + eps)
def _scatter_add(tgt, idx, src, axis=0):
    return tgt.clone().index_add_(axis, idx, src)
def _segment_sum(src, seg, n):
    out = torch.zeros((n,) + src.shape[1:], dtype=src.dtype)
    return out.index_add_(0, seg, src)
def _pad(x, pw):
    flat = tuple(v for pair in reversed(pw) for v in pair)
    return torch.nn.functional.pad(x, flat)

kernel_name = 'gated_mix__spectral_fnet__linear_kernel_hedgehog__prompt'

def setup_inputs():

    _w = (lambda a: (lambda t: t.to(torch.bfloat16) if t.is_floating_point() else t)(torch.as_tensor(a)))
    def _A_setup():
        B, S, D = 1, 2048, 576
        ns = torch.arange(S)[:, None] * torch.arange(S)[None, :]
        nd = torch.arange(D)[:, None] * torch.arange(D)[None, :]
        Ws_re = torch.cos(-2.0 * torch.pi * ns / S).to(float)
        Ws_im = torch.sin(-2.0 * torch.pi * ns / S).to(float)
        Wd_re = torch.cos(-2.0 * torch.pi * nd / D).to(float)
        Wd_im = torch.sin(-2.0 * torch.pi * nd / D).to(float)
        return {
            "x": _w((lambda *s: torch.randn(*s, dtype=torch.bfloat16) * 0.1)(B, S, D)),
            "dft_seq_re": _w(Ws_re),
            "dft_seq_im": _w(Ws_im),
            "dft_hid_re": _w(Wd_re),
            "dft_hid_im": _w(Wd_im),
        }
    _A_in = _A_setup()

    def _B_setup():
        B, S, D, H = 1, 2048, 576, 32
        Dh = D // H
        return {
            "x": _w((lambda *s: torch.randn(*s, dtype=torch.bfloat16) * 0.1)(B, S, D)),
            "wqkv": _w((lambda *s: torch.randn(*s, dtype=torch.bfloat16) * 1.6)(D, 3 * D)),
            "w_phi": _w((lambda *s: torch.randn(*s, dtype=torch.bfloat16) * 1.6)(H, Dh, Dh) * (Dh ** -0.5)),
            "wo": _w((lambda *s: torch.randn(*s, dtype=torch.bfloat16) * 1.6)(D, D)),
        }
    _B_in = _B_setup()

    return {
        "A_x": _A_in["x"],
        "A_dft_seq_re": _A_in["dft_seq_re"],
        "A_dft_seq_im": _A_in["dft_seq_im"],
        "A_dft_hid_re": _A_in["dft_hid_re"],
        "A_dft_hid_im": _A_in["dft_hid_im"],
        "B_x": _B_in["x"],
        "B_wqkv": _B_in["wqkv"],
        "B_w_phi": _B_in["w_phi"],
        "B_wo": _B_in["wo"],
        "gate_w": _w((lambda *s: torch.randn(*s, dtype=torch.bfloat16) * 0.1)(576) * 16.0),
    }

def reference(A_x, A_dft_seq_re, A_dft_seq_im, A_dft_hid_re, A_dft_hid_im, B_x, B_wqkv, B_w_phi, B_wo, gate_w):
    def _A_ref(x, dft_seq_re, dft_seq_im, dft_hid_re, dft_hid_im):
        a = torch.einsum("bsd,ed->bse", x, dft_hid_re)
        b = torch.einsum("bsd,ed->bse", x, dft_hid_im)
        y = torch.einsum("ts,bse->bte", dft_seq_re, a) - torch.einsum("ts,bse->bte", dft_seq_im, b)
        return y

    def _B_ref(x, wqkv, w_phi, wo):
        B, S, D = x.shape
        H = 32; Dh = D // H
        qkv = (lambda x, *d: x.permute(*d))((x @ wqkv).reshape(B, S, 3, H, Dh), 2, 0, 3, 1, 4)
        q, k, v = qkv[0], qkv[1], qkv[2]
        pq = torch.einsum("bhsd,hdf->bhsf", q, w_phi)
        pk = torch.einsum("bhsd,hdf->bhsf", k, w_phi)
        phi_q = torch.concatenate([_softmax(pq, axis=-1), _softmax(-pq, axis=-1)], axis=-1)
        phi_k = torch.concatenate([_softmax(pk, axis=-1), _softmax(-pk, axis=-1)], axis=-1)
        kv = torch.einsum("bhsf,bhsd->bhfd", phi_k, v)
        z  = torch.einsum("bhsf->bhf", phi_k)
        num = torch.einsum("bhqf,bhfd->bhqd", phi_q, kv)
        den = torch.einsum("bhqf,bhf->bhq", phi_q, z)[..., None] + 1e-6
        o = num / den
        return (lambda x, *d: x.permute(*d))(o, 0, 2, 1, 3).reshape(B, S, D) @ wo

    x = A_x
    g = _sigmoid((x * gate_w).sum(-1, keepdims=True))
    a = _A_ref(x, A_dft_seq_re, A_dft_seq_im, A_dft_hid_re, A_dft_hid_im)
    b = _B_ref(x, B_wqkv, B_w_phi, B_wo)
    return g * a + (1 - g) * b
```

```asm
; @launch grid=(256,1,1) block=(512,1,1) lds=163840
.amdgcn_target "amdgcn-amd-amdhsa--gfx950"
.text
.p2align 12
.fill 832, 4, 0xbf800000
.globl gated_mix__spectral_fnet__linear_kernel_hedgehog__prompt_kernel
.p2align 8
.type gated_mix__spectral_fnet__linear_kernel_hedgehog__prompt_kernel,@function
gated_mix__spectral_fnet__linear_kernel_hedgehog__prompt_kernel:
  s_cmp_ge_u32 s2, 256
  s_cbranch_scc1 L_end
  v_lshrrev_b32 v1, 6, v0
  v_and_b32 v0, 63, v0
  v_readfirstlane_b32 s4, v1
  s_cmp_ge_u32 s4, 4
  s_cselect_b32 s46, 0, 48
  s_load_dwordx4 s[8:11], s[0:1], s46
  s_mov_b64 s[40:41], s[0:1]
  s_mov_b64 s[54:55], s[0:1]
  s_mov_b64 s[52:53], s[0:1]
  s_mov_b64 s[48:49], s[0:1]
  s_lshl_b32 s47, s2, 3
  s_add_u32 s47, s47, s4
  s_cmp_lg_u32 s47, 1592
  s_cbranch_scc1 L_nl0
  s_load_dwordx8 s[48:55], s[0:1], 64
  s_load_dwordx2 s[40:41], s[0:1], 96
L_nl0:
  s_lshr_b32 s7, s2, 3
  s_getpc_b64 s[84:85]
  s_lshl_b32 s3, s7, 3
  v_and_b32 v1, 15, v0
  v_lshrrev_b32_e64 v2, 4, v0
  s_add_u32 s3, s3, s4
  s_min_u32 s3, s3, 176
  s_lshl_b32 s3, s3, 7
  v_mov_b32 v4, s3
  global_load_dword v7, v4, s[84:85]
  v_lshlrev_b32_e64 v3, 4, v0
  s_mov_b32 s93, s4
  s_mov_b64 exec, -1
  s_and_b32 s5, s2, 3
  s_lshl_b32 s5, s5, 2
  s_and_b32 s3, s7, 3
  s_add_u32 s5, s5, s3
  s_bfe_u32 s56, s2, 0x10002
  s_lshl_b32 s6, s56, 3
  s_lshr_b32 s3, s7, 2
  s_add_u32 s6, s6, s3
  s_add_u32 s56, s56, s3
  s_mov_b32 s42, 16777216
  s_mov_b32 s43, 0x20000
  v_mov_b32 v20, 0
  v_mov_b32 v21, 0
  v_mov_b32 v22, 0
  v_mov_b32 v23, 0
  v_mov_b32 v24, 0
  v_mov_b32 v25, 0
  v_mov_b32_e64 v26, 0
  s_cmp_ge_u32 s4, 4
  s_cbranch_scc0 L_A
  s_load_dwordx2 s[28:29], s[0:1], 72
  s_and_b32 s4, s4, 3
  s_mul_i32 s45, s4, 18
  v_add_u32 v4, s45, v0
  v_lshrrev_b32 v5, 3, v4
  v_add_u32 v5, s56, v5
  v_subrev_u32 v6, 9, v5
  v_min_u32 v5, v5, v6
  v_and_b32 v4, 7, v4
  v_lshlrev_b32_e64 v4, 4, v4
  v_lshl_add_u32 v6, v5, 7, v4
  s_lshl_b32 s45, s45, 4
  s_add_u32 m0, s45, 162432
  s_mov_b32 s30, 1152
  s_mov_b32 s31, 0x20000
  s_lshl_b32 s3, s5, 2
  s_add_u32 s83, s3, s4
  s_mul_i32 s3, s83, 1152
  v_lshrrev_b32 v4, 3, v0
  v_mul_u32_u24 v4, 73728, v4
  v_and_b32 v5, 7, v0
  v_xor_b32 v5, v5, v2
  v_lshlrev_b32_e64 v5, 4, v5
  v_add3_u32 v16, v4, v5, s3
  v_xor_b32_e64 v17, 64, v16
  v_add_u32 v18, 1177600, v16
  v_add_u32 v19, 1766400, v17
  v_add_u32 v17, 588800, v17
  s_lshl_b32 s84, s4, 12
  s_mov_b64 exec, 0x3ffff
  s_waitcnt lgkmcnt(0)
  s_mov_b32 s10, 2359296
  s_mov_b32 s11, 0x20000
  s_lshl_b32 s3, s56, 7
  s_barrier
  buffer_load_dwordx4 v6, s[28:31], 0 offen lds
  s_mov_b32 m0, s84
  s_mov_b64 exec, -1
  buffer_load_dwordx4 v16, s[8:11], s3 offen offset:0 lds
  buffer_load_dwordx4 v17, s[8:11], s3 offen offset:1024 lds
  buffer_load_dwordx4 v18, s[8:11], s3 offen offset:2048 lds
  buffer_load_dwordx4 v19, s[8:11], s3 offen offset:3072 lds
  s_branch L_B2
L_A:
  s_and_b32 s80, s4, 1
  s_and_b32 s81, s7, 7
  s_sub_u32 s82, s2, 1
  s_and_b32 s82, s82, 7
  s_lshl_b32 s82, s82, 2
  s_lshr_b32 s3, s2, 6
  s_add_u32 s82, s82, s3
  s_lshl_b32 s83, s82, 1
  s_lshr_b32 s3, s4, 1
  s_add_u32 s83, s83, s3
  v_mul_u32_u24 v13, 57, v0
  v_lshrrev_b32_e64 v13, 9, v13
  s_lshl_b32 s92, s81, 1
  s_add_u32 s92, s92, s80
  s_mul_i32 s92, s92, 129024
  s_add_u32 s92, s92, 65536
  s_mov_b32 s18, 20736
  s_mov_b32 s19, 0x20000
  s_mov_b32 s90, 0
  s_cmp_ge_u32 s83, 54
  s_cbranch_scc1 L_nofold
  s_mul_i32 s84, s3, 4608
  s_add_u32 s84, s84, 49152
  s_cmp_ge_u32 s83, 18
  s_cselect_b32 s85, 1, 0
  s_cmp_ge_u32 s83, 36
  s_cselect_b32 s85, 2, s85
  s_mul_i32 s3, s85, 18
  s_sub_u32 s86, s83, s3
  v_mul_u32_u24 v5, 3312, v13
  v_add_u32 v16, v5, v3
  v_mul_u32_u24 v4, 26, v0
  v_lshrrev_b32 v4, 8, v4
  v_sub_u32 v4, v0, v4
  v_lshlrev_b32 v17, 2, v4
  s_lshl_b32 s90, s86, 1
  s_add_u32 s90, s90, s80
  s_mul_i32 s90, s90, 55296
  s_mul_i32 s3, s85, 1152
  s_add_u32 s90, s90, s3
  s_mul_i32 s3, s81, 144
  s_add_u32 s90, s90, s3
  s_lshl_b32 s91, s81, 2
  s_add_u32 s91, s91, s4
  s_mul_i32 s91, s91, 648
  s_mul_i32 s79, s80, 2304
  s_add_u32 s79, s79, s84
  s_mul_i32 s78, s4, 720
  s_waitcnt lgkmcnt(0)
  s_mov_b64 s[16:17], s[10:11]
  s_mov_b32 s10, 1990656
  s_mov_b32 s11, 0x20000
  s_mov_b32 exec_hi, 0x3fffff
  s_add_u32 m0, s79, 0
  s_nop 0
  buffer_load_dwordx4 v16, s[8:11], s90 offen lds
  s_add_u32 s90, s90, 20736
  s_add_u32 m0, s79, 864
  s_nop 0
  buffer_load_dwordx4 v16, s[8:11], s90 offen lds
  s_add_u32 s90, s90, 20736
  s_add_u32 m0, s79, 1728
  s_mov_b32 exec_hi, 15
  buffer_load_dwordx4 v16, s[8:11], s90 offen lds
  s_mov_b64 exec, -1
  s_cmp_ge_u32 s85, 2
  s_cbranch_scc1 L_vjob
  s_add_u32 m0, s78, 58368
  s_nop 0
  buffer_load_dword v17, s[16:19], s91 offen lds
  s_add_u32 s91, s91, 216
  s_add_u32 m0, s78, 58608
  s_nop 0
  buffer_load_dword v17, s[16:19], s91 offen lds
  s_add_u32 s91, s91, 216
  s_add_u32 m0, s78, 58848
  s_nop 0
  buffer_load_dword v17, s[16:19], s91 offen lds
  s_barrier
  v_mov_b32_e64 v24, v3
  v_add_u32 v25, 1024, v3
  s_cmp_eq_u32 s85, 0
  s_cselect_b32 s90, 10240, 0
  s_cselect_b32 s91, 512, 0
  s_cselect_b32 s3, 2, 0
  v_xor_b32 v26, s3, v2
  v_lshlrev_b32 v26, 6, v26
  s_mul_i32 s78, s80, 1440
  s_add_u32 s78, s78, 58368
L_pad1:
  s_branch L_job
L_nofold:
  s_cmp_lg_u32 s47, 1592
  s_cbranch_scc1 L_idle
L_lead:
  v_mul_u32_u24 v4, 1152, v0
  v_mul_u32_u24 v5, 640, v0
  s_waitcnt lgkmcnt(0)
  s_mov_b32 s3, 7929856
  buffer_store_dwordx4 v[20:23], v4, s[40:43], s3 offen sc1
  s_load_dword s20, s[54:55], 0 glc
  s_mov_b32 s3, 8028160
  buffer_store_dword v20, v5, s[40:43], s3 offen sc1
  s_mov_b32 s3, 8069120
  buffer_store_dword v20, v5, s[40:43], s3 offen sc1
  s_barrier
  s_mov_b32 s21, 1
  s_waitcnt vmcnt(0) lgkmcnt(0)
  s_atomic_add s21, s[54:55], 0
  s_load_dwordx2 s[40:41], s[0:1], 96
  s_mov_b32 s47, 2
  s_branch L_com
L_idle:
  s_barrier
  s_load_dwordx8 s[48:55], s[0:1], 64
  s_load_dwordx2 s[40:41], s[0:1], 96
  s_mov_b32 s47, 2
  s_branch L_com
L_vjob:
  s_barrier
  s_cmp_lg_u32 s4, 0
  s_cbranch_scc1 L_noid
  v_add_u32 v4, 61264, v3
  ds_write_b128 v4, v[20:23]
  s_mov_b64 exec, 0x7ffffff
  ds_write_b128 v4, v[20:23] offset:1024
  s_mov_b32 exec_lo, 0xffffffff
  s_mov_b32 exec_hi, 0xf
  v_cmp_le_u32 vcc, 18, v0
  v_mul_u32_u24 v4, 42, v0
  v_mov_b32 v6, 0x3f80
  v_cndmask_b32 v5, 0, 36, vcc
  v_sub_u32_e64 v4, v4, v5
  v_add_u32 v4, 61264, v4
  ds_write_b16 v4, v6
  s_mov_b64 exec, -1
L_noid:
  v_lshrrev_b32 v4, 3, v1
  v_lshlrev_b32_e64 v4, 10, v4
  v_lshl_add_u32 v4, v2, 8, v4
  v_bfe_u32 v5, v1, 2, 1
  v_lshl_add_u32 v4, v5, 7, v4
  v_and_b32_e64 v5, 3, v1
  v_lshl_add_u32 v24, v5, 4, v4
  v_add_u32_e64 v25, 64, v24
  s_mov_b32 s90, 6144
  s_mov_b32 s91, 256
  v_xor_b32 v26, 1, v2
  v_lshlrev_b32 v26, 6, v26
  s_mov_b32 s78, 61264
L_job:
  s_load_dwordx8 s[48:55], s[0:1], 64
  s_load_dwordx2 s[40:41], s[0:1], 96
  s_mov_b32 s47, 0
  v_mov_b32 v18, 62720
  ds_write_b128 v18, v[20:23]
  v_lshrrev_b32 v4, 2, v1
  v_lshl_add_u32 v26, v4, 5, v26
  v_and_b32_e64 v5, 1, v1
  v_lshl_add_u32 v26, v5, 4, v26
  s_lshr_b32 s3, s86, 1
  s_mul_i32 s3, s3, 14336
  s_add_u32 s92, s92, s3
  s_and_b32 s86, s86, 1
  s_lshl_b32 s3, s86, 11
  s_add_u32 s90, s90, s3
  s_add_u32 s90, s90, s92
  s_lshl_b32 s3, s86, 10
  s_add_u32 s91, s91, s3
  s_add_u32 s91, s91, s92
  s_add_u32 s91, s91, 4096
  v_and_b32 v5, 3, v1
  v_lshl_add_u32 v5, v4, 3, v5
  v_mul_u32_u24 v5, 144, v5
  s_mul_i32 s3, s80, 72
  s_add_u32 s3, s3, s84
  v_add_u32 v28, s3, v5
  v_lshl_add_u32 v27, v2, 4, v28
  v_lshl_add_u32 v5, v2, 3, v4
  v_mul_u32_u24 v5, 40, v5
  v_add_u32 v5, s78, v5
  v_and_b32_e64 v6, 1, v0
  v_lshl_add_u32 v6, v6, 4, v5
  v_add_u32 v5, 32, v5
  v_mov_b32 v30, v18
  v_mov_b32 v31, v18
  v_mov_b32 v32, v18
  v_mov_b32 v33, v18
  v_mov_b32 v34, v18
  v_mov_b32_e64 v35, v18
  s_mov_b32 exec_lo, 0x33333333
  s_mov_b32 exec_hi, 0xcccccc33
  v_add_u32_e64 v30, 0, v6
  s_mov_b32 exec_lo, 0x33333333
  s_mov_b32 exec_hi, 0xcccccccc
  v_add_u32 v31, 160, v6
  s_mov_b64 exec, 0xcccc
  v_add_u32 v32, 1280, v6
  s_mov_b32 exec_lo, 0x55555555
  s_mov_b32 exec_hi, 0xaaaaaa55
  v_add_u32_e64 v33, 0, v5
  s_mov_b32 exec_lo, 0x55555555
  s_mov_b32 exec_hi, 0xaaaaaaaa
  v_add_u32 v34, 160, v5
  s_mov_b64 exec, 0xaaaa
  v_add_u32 v35, 1280, v5
  s_mov_b64 exec, -1
L_com:
  s_mov_b64 exec, 0
  s_cmp_eq_u32 s4, 0
  s_cbranch_scc1 L_pad4
L_retcom:
  s_mov_b64 exec, -1
  v_lshlrev_b32 v4, 2, v1
  v_add_u32 v4, 163776, v4
  ds_write_b32 v4, v20
  s_mul_i32 s32, s6, 129024
  s_add_u32 s32, s32, 65536
  s_mul_i32 s3, s56, 14336
  s_add_u32 s65, s32, s3
  s_add_u32 s33, s32, 129024
  s_add_u32 s66, s65, 14336
  s_cmp_eq_u32 s66, s33
  s_cselect_b32 s66, s32, s66
  s_add_u32 s67, s66, 14336
  s_cmp_eq_u32 s67, s33
  s_cselect_b32 s67, s32, s67
  s_add_u32 s68, s67, 14336
  s_cmp_eq_u32 s68, s33
  s_cselect_b32 s68, s32, s68
  s_add_u32 s69, s68, 14336
  s_cmp_eq_u32 s69, s33
  s_cselect_b32 s69, s32, s69
  s_add_u32 s70, s69, 14336
  s_cmp_eq_u32 s70, s33
  s_cselect_b32 s70, s32, s70
  s_add_u32 s71, s70, 14336
  s_cmp_eq_u32 s71, s33
  s_cselect_b32 s71, s32, s71
  s_add_u32 s72, s71, 14336
  s_cmp_eq_u32 s72, s33
  s_cselect_b32 s72, s32, s72
  s_add_u32 s73, s72, 14336
  s_cmp_eq_u32 s73, s33
  s_cselect_b32 s73, s32, s73
  v_bfe_u32 v8, v0, 1, 3
  v_lshrrev_b32 v9, 5, v0
  v_xor_b32 v8, v8, v9
  v_lshlrev_b32 v8, 4, v8
  v_and_b32_e64 v9, 31, v0
  v_lshl_add_u32 v8, v9, 7, v8
  s_lshl_b32 s3, s4, 12
  v_add_u32 v8, s3, v8
  v_xor_b32 v9, 32, v8
  v_xor_b32 v62, 64, v8
  v_xor_b32 v63, 0x60, v8
  s_lshl_b32 s84, s4, 10
  s_lshl_b32 s85, s4, 9
  v_add_u32_e64 v70, s84, v3
  v_add_u32 v10, 6144, v70
  v_add_u32 v12, 10240, v70
  s_add_u32 s3, s85, 4096
  v_add_u32_e64 v11, s3, v3
  s_mul_i32 s33, s81, 9216
L_pad2:
  s_add_u32 s33, s33, 7929856
  s_sub_u32 s82, s82, 14
  s_lshr_b32 s3, s4, 1
  s_mul_i32 s22, s3, 18
  s_lshl_b32 s3, s80, 3
  s_add_u32 s22, s22, s3
  s_mul_i32 s3, s82, 36
  s_add_u32 s22, s22, s3
  s_sub_u32 s3, s82, 16
  s_lshl_b32 s3, s3, 2
  s_add_u32 s3, s3, s4
  s_mul_i32 s3, s3, 72
  s_add_u32 s3, s3, 16
  s_cmp_ge_u32 s82, 16
  s_cselect_b32 s22, s3, s22
  s_cselect_b32 s76, 36, 4
  s_cselect_b32 s3, 18432, 0
  v_lshrrev_b32 v4, 1, v13
  v_mul_u32_u24 v4, s3, v4
  v_mul_u32_u24 v5, 1008, v13
  v_add3_u32 v60, v4, v5, v3
  s_lshl_b32 s22, s22, 3
  s_add_u32 s22, s22, s81
  s_mulk_i32 s22, 144
  s_mulk_i32 s76, 1152
  s_add_u32 s76, s76, s22
  s_cmp_lt_u32 s82, 18
  s_cselect_b32 s34, 663552, 0
  s_cselect_b32 s22, s22, 0
  s_cselect_b32 s76, s76, 0
  s_mul_i32 s35, s4, 1152
  s_lshl_b32 s23, s47, 2
  s_add_u32 s23, s23, s4
  s_bitcmp1_b32 s4, 0
  s_cselect_b32 s44, 0xffff, -1
  s_mov_b32 s45, 0
  s_mul_i32 s46, s6, 4608
  s_add_u32 s46, s46, 7929860
  s_and_b32 s3, s2, 3
  s_mul_i32 s3, s3, 1152
  s_add_u32 s30, s46, s3
  s_sub_u32 s92, s30, 4
  s_waitcnt lgkmcnt(0)
  s_mov_b64 s[8:9], s[48:49]
  s_mov_b32 s10, s34
  s_mov_b32 s11, 0x20000
  s_add_u32 m0, s35, 114688
  s_mov_b32 exec_hi, 15
  buffer_load_dwordx4 v60, s[8:11], s22 offen lds
  s_add_u32 m0, s35, 115264
  s_nop 0
  buffer_load_dwordx4 v60, s[8:11], s76 offen lds
  s_mov_b32 exec_hi, -1
  s_and_b32 s12, s7, 7
  s_and_b32 s13, s2, 7
  s_lshl_b32 s13, s13, 1
  s_bfe_u32 s3, s7, 0x10003
  s_add_u32 s13, s13, s3
  s_sub_u32 s14, 32, s13
  s_cmp_eq_u32 s13, 0
  s_cselect_b32 s14, 16, s14
  s_cmp_ge_u32 s7, 16
  s_cselect_b32 s14, s14, s13
  v_and_b32 v76, 7, v1
  v_lshrrev_b32 v77, 1, v76
  v_and_b32 v76, 1, v76
  v_lshlrev_b32 v76, 4, v76
  v_mov_b32 v78, 0x3f80
  v_lshlrev_b32 v76, v76, v78
  v_cmp_eq_u32 vcc, 0, v77
  s_nop 1
  v_cndmask_b32 v72, 0, v76, vcc
  v_cmp_eq_u32 vcc, 1, v77
  s_nop 1
  v_cndmask_b32 v73, 0, v76, vcc
  v_cmp_eq_u32 vcc, 2, v77
  s_nop 1
  v_cndmask_b32 v74, 0, v76, vcc
  v_cmp_eq_u32 vcc, 3, v77
  s_nop 1
  v_cndmask_b32_e64 v75, 0, v76, vcc
  v_mul_u32_u24 v76, 3072, v2
  v_lshl_add_u32 v76, v1, 4, v76
  s_mul_i32 s3, s4, 768
  v_add_u32 v76, s3, v76
  v_and_b32 v77, 1, v2
  v_lshlrev_b32_e64 v77, 3, v77
  v_lshl_add_u32 v77, v1, 4, v77
  s_add_u32 s3, s3, 157696
  v_add_u32_e64 v77, s3, v77
  s_mul_i32 s56, s6, 49152
  s_add_u32 s56, s56, 2162688
  s_add_u32 s57, s56, 12288
  s_add_u32 s58, s56, 24576
  s_add_u32 s59, s56, 36864
  s_mul_i32 s75, s6, 5120
  s_add_u32 s75, s75, 8028160
  v_mov_b32 v78, 2147483632
  s_cmp_eq_u32 s4, 3
  s_cselect_b32 vcc_lo, 0xfff0fff0, 0
  s_mov_b32 vcc_hi, vcc_lo
  v_cndmask_b32_e64 v78, v76, v78, vcc
  s_mul_i32 s3, s5, 3072
  s_add_u32 s17, s56, s3
  s_mul_i32 s3, s4, 768
  s_add_u32 s17, s17, s3
  s_lshl_b32 s3, s5, 2
  s_add_u32 s3, s3, s4
  s_mul_i32 s18, s3, 36864
  s_add_u32 s18, s18, 5505024
  s_lshl_b32 s3, s6, 7
  s_add_u32 s20, s18, s3
  s_add_u32 s20, s20, 16384
  s_lshl_b32 s3, s6, 10
  s_add_u32 s18, s18, s3
  s_add_u32 s19, s18, 18432
  v_lshrrev_b32_e64 v4, 5, v0
  v_mul_u32_u24 v4, 18304, v4
  v_lshl_add_u32 v82, v0, 2, v4
  v_mov_b32 v84, -1
  v_mov_b32 v85, -1
  v_mov_b32 v86, -1
  v_mov_b32 v87, -1
  s_mul_i32 s78, s12, 72
  s_sub_u32 s3, 576, s78
  s_cmp_ge_u32 s12, 4
  s_cselect_b32 s78, s3, s78
  s_cselect_b32 s79, -16, 16
  s_cselect_b32 s80, 2, 1
  s_lshl_b32 s3, s13, 4
  s_lshl_b32 s77, s4, 2
  s_add_u32 s3, s3, s77
  s_mul_i32 s3, s3, 576
  s_add_u32 s3, s3, s78
  s_lshl_b32 s3, s3, 4
  s_add_u32 s3, s3, 3145728
  v_mul_lo_u32 v4, v0, s79
  v_add_u32 v79, s3, v4
  v_and_b32 v4, 7, v0
  v_add_u32 v4, 64, v4
  v_mul_lo_u32 v4, v4, s79
  v_bfe_u32 v5, v0, 3, 2
  v_mul_u32_u24 v5, 9216, v5
  v_add3_u32 v4, v4, v5, s3
  v_lshrrev_b32_e64 v5, 5, v0
  v_mul_u32_u24 v5, 4608, v5
  v_add_u32_e64 v81, v4, v5
  v_mov_b32 v80, 2147483632
  s_and_b32 s3, s12, 3
  s_cmp_eq_u32 s3, 0
  s_cselect_b32 vcc_lo, 1, 0
  s_mov_b32 vcc_hi, 0
  v_cndmask_b32_e64 v80, v79, v80, vcc
  s_sub_u32 s77, 7, s12
  s_min_u32 s77, s77, s12
  s_mul_i32 s60, s77, 10240
  s_and_b32 s3, s2, 7
  s_mul_i32 s3, s3, 640
  s_add_u32 s3, s3, 8028160
  s_add_u32 s60, s60, s3
  s_add_u32 s61, s60, 5120
  s_mul_i32 s62, s80, 5120
  s_add_u32 s62, s62, s60
  s_add_u32 s63, s60, 40960
  s_add_u32 s64, s61, 40960
  s_add_u32 s74, s62, 40960
  s_add_u32 s3, s3, 76800
  s_min_u32 s74, s74, s3
  s_mul_i32 s77, s4, 9216
  s_setprio 2
  s_cmp_lg_u32 s47, 0
  s_waitcnt vmcnt(2) lgkmcnt(0)
  s_barrier
  s_cbranch_scc1 L_A2
  ds_read_b64 v[112:113], v27 offset:0
  ds_read_b64 v[114:115], v27 offset:8
  ds_read_b64 v[116:117], v27 offset:576
  ds_read_b64 v[118:119], v27 offset:584
  ds_read_b64_tr_b16 v[124:125], v30 offset:0
  ds_read_b64_tr_b16 v[126:127], v31 offset:0
  ds_read_b64 v[120:121], v28 offset:64
L_pad3:
  ds_read_b64 v[122:123], v28 offset:640
  ds_read_b64_tr_b16 v[136:137], v32 offset:0
  ds_read_b64_tr_b16 v[128:129], v30 offset:8
  ds_read_b64_tr_b16 v[130:131], v31 offset:8
  ds_read_b64_tr_b16 v[138:139], v32 offset:8
  ds_read_b64_tr_b16 v[132:133], v33 offset:0
  ds_read_b64_tr_b16 v[134:135], v34 offset:0
  ds_read_b64_tr_b16 v[140:141], v35 offset:0
  s_waitcnt lgkmcnt(9)
  v_mfma_f32_16x16x32_bf16 v[144:147], v[112:115], v[124:127], 0
  v_mfma_f32_16x16x32_bf16 v[148:151], v[116:119], v[124:127], 0
  s_waitcnt lgkmcnt(6)
  v_mfma_f32_16x16x16_bf16 v[144:147], v[120:121], v[136:137], v[144:147]
  v_mfma_f32_16x16x16_bf16 v[148:151], v[122:123], v[136:137], v[148:151]
  s_waitcnt lgkmcnt(4)
  v_mfma_f32_16x16x32_bf16 v[152:155], v[112:115], v[128:131], 0
  v_mfma_f32_16x16x32_bf16 v[156:159], v[116:119], v[128:131], 0
  s_waitcnt lgkmcnt(3)
  v_mfma_f32_16x16x16_bf16 v[152:155], v[120:121], v[138:139], v[152:155]
  v_mfma_f32_16x16x16_bf16 v[156:159], v[122:123], v[138:139], v[156:159]
  s_nop 0
  v_cvt_pk_bf16_f32 v168, v144, v145
  v_cvt_pk_bf16_f32 v169, v146, v147
  v_cvt_pk_bf16_f32 v170, v148, v149
  v_cvt_pk_bf16_f32 v171, v150, v151
  buffer_store_dwordx4 v[168:171], v24, s[40:43], s90 offen sc1
  s_waitcnt lgkmcnt(1)
  v_mfma_f32_16x16x32_bf16 v[160:163], v[112:115], v[132:135], 0
  v_mfma_f32_16x16x32_bf16 v[164:167], v[116:119], v[132:135], 0
  s_waitcnt lgkmcnt(0)
  v_mfma_f32_16x16x16_bf16 v[160:163], v[120:121], v[140:141], v[160:163]
  v_mfma_f32_16x16x16_bf16 v[164:167], v[122:123], v[140:141], v[164:167]
  v_cvt_pk_bf16_f32 v172, v152, v153
  v_cvt_pk_bf16_f32 v173, v154, v155
  v_cvt_pk_bf16_f32 v174, v156, v157
  v_cvt_pk_bf16_f32 v175, v158, v159
  buffer_store_dwordx4 v[172:175], v25, s[40:43], s90 offen sc1
  s_nop 1
  v_cvt_pk_bf16_f32 v176, v160, v161
  v_cvt_pk_bf16_f32 v177, v162, v163
  v_cvt_pk_bf16_f32 v178, v164, v165
  v_cvt_pk_bf16_f32 v179, v166, v167
  s_mov_b32 exec_lo, 0x330033
  s_mov_b32 exec_hi, 0x330033
  buffer_store_dwordx4 v[176:179], v26, s[40:43], s91 offen sc1
  s_mov_b64 exec, -1
L_A2:
  s_setprio 0
  s_barrier
  s_mov_b32 s36, s54
  s_mov_b32 s37, s55
  s_mov_b32 s38, 256
  s_mov_b32 s39, 0x20000
  s_cmp_lg_u32 s4, 0
  s_cbranch_scc1 L_nord
  s_load_dword s0, s[54:55], 0
L_nord:
  v_lshrrev_b32_e64 v4, 2, v0
  v_mul_u32_u24 v4, 160, v4
  s_and_b32 s3, s4, 1
  s_mul_i32 s86, s3, 80
  s_add_u32 s86, s86, 36864
  v_add_u32 v4, s86, v4
  v_and_b32_e64 v5, 3, v0
  v_lshl_add_u32 v64, v5, 3, v4
  v_min_u32_e64 v5, 1, v5
  v_lshl_add_u32 v4, v5, 18, v4
  v_add_u32 v65, 64, v4
  s_lshl_b32 s86, s3, 10
  s_add_u32 s86, s86, 57344
  v_add_u32 v66, s86, v3
  s_lshl_b32 s86, s4, 11
  s_add_u32 s86, s86, 57344
  v_and_b32 v4, 1, v2
  v_lshlrev_b32 v4, 10, v4
  v_lshrrev_b32_e64 v5, 1, v2
  v_lshl_add_u32 v4, v5, 8, v4
  v_lshl_add_u32 v83, v1, 4, v4
  v_add_u32_e64 v14, s86, v83
  s_mul_i32 s86, s3, 1440
  s_lshr_b32 s3, s4, 1
  s_lshl_b32 s3, s3, 4
  v_add_u32_e64 v4, s3, v1
  v_mul_u32_u24 v5, 320, v2
  v_lshl_add_u32 v69, v4, 4, v5
  v_lshlrev_b32_e64 v71, 3, v4
  s_lshl_b32 s3, s6, 4
  s_add_u32 s3, s3, s5
  s_mul_i32 s3, s3, 3072
  s_add_u32 s86, s86, s3
  s_add_u32 s86, s86, 2162688
  s_mul_i32 s3, s12, 82944
  s_add_u32 s3, s3, 9437184
  s_add_u32 s28, s40, s33
  s_addc_u32 s29, s41, 0
  s_mov_b32 s1, 1
  s_add_u32 s24, s40, s3
  s_addc_u32 s25, s41, 0
  s_mov_b32 s26, 82944
  s_mov_b32 s27, 0x20000
  v_lshrrev_b32 v36, 1, v1
  v_cvt_f32_u32 v36, v36
  v_and_b32 v37, 1, v1
  v_cvt_f32_u32 v37, v37
  v_mul_f32 v37, 0xbe800000, v37
  v_lshlrev_b32 v38, 2, v2
  v_cvt_f32_u32 v38, v38
  v_add_f32 v39, 0x41000000, v36
  v_mul_f32 v39, 0x3d000000, v39
  v_fma_f32 v16, v39, v38, v37
  v_fmamk_f32 v17, v39, 0x3f800000, v16
  v_fmamk_f32 v18, v39, 0x40000000, v16
  v_fmamk_f32 v19, v39, 0x40400000, v16
  v_fmamk_f32 v20, v39, 0x41800000, v16
  v_fmamk_f32 v21, v39, 0x41880000, v16
  v_fmamk_f32 v22, v39, 0x41900000, v16
  v_fmamk_f32 v23, v39, 0x41980000, v16
  v_cos_f32 v16, v16
  v_cos_f32 v17, v17
  v_cos_f32 v18, v18
  v_cos_f32 v19, v19
  v_cos_f32 v20, v20
  v_cos_f32 v21, v21
  v_cos_f32 v22, v22
  v_cos_f32 v23, v23
  v_cvt_pk_bf16_f32 v92, v16, v17
  v_cvt_pk_bf16_f32 v93, v18, v19
  v_cvt_pk_bf16_f32 v94, v20, v21
  v_cvt_pk_bf16_f32 v95, v22, v23
  v_mov_b32_e64 v39, v36
  s_mov_b32 exec_lo, 0x20002
  s_mov_b32 exec_hi, 0x20002
  v_mov_b32 v39, 0x41800000
  v_mov_b32 v37, 0
  s_mov_b64 exec, -1
  v_mul_f32 v39, 0x3d000000, v39
  v_fma_f32 v16, v39, v38, v37
  v_fmamk_f32 v17, v39, 0x3f800000, v16
  v_fmamk_f32 v18, v39, 0x40000000, v16
  v_fmamk_f32 v19, v39, 0x40400000, v16
  v_fmamk_f32 v20, v39, 0x41800000, v16
  v_fmamk_f32 v21, v39, 0x41880000, v16
  v_fmamk_f32 v22, v39, 0x41900000, v16
  v_fmamk_f32 v23, v39, 0x41980000, v16
  v_cos_f32 v16, v16
  v_cos_f32 v17, v17
  v_cos_f32 v18, v18
  v_cos_f32 v19, v19
  v_cos_f32 v20, v20
  v_cos_f32 v21, v21
  v_cos_f32 v22, v22
  v_cos_f32 v23, v23
  v_cvt_pk_bf16_f32 v88, v16, v17
  v_cvt_pk_bf16_f32 v89, v18, v19
  v_cvt_pk_bf16_f32 v90, v20, v21
  v_cvt_pk_bf16_f32 v91, v22, v23
  s_cmp_lg_u32 s4, 0
  s_cbranch_scc1 L_rdy
  s_waitcnt lgkmcnt(0)
  s_cmp_lg_u32 s0, 0
L_pad4:
  s_cbranch_execz L_retcom
  s_cbranch_scc1 L_rdy
  s_mov_b32 s87, 0
L_pl4:
  buffer_load_dword v7, off, s[36:39], 0 sc1
  s_add_u32 s87, s87, 1
  s_cmp_gt_u32 s87, 200000
  s_cbranch_scc1 L_pe5
L_pc6:
  s_waitcnt vmcnt(0)
  v_cmp_gt_u32_e64 vcc, 1, v7
  s_cbranch_vccnz L_pl4
L_pe5:
  s_waitcnt vmcnt(0)
L_rdy:
  s_mov_b64 exec, 0
  s_cmp_eq_u32 s4, 2
  s_cbranch_scc1 L_pad16
  s_cmp_eq_u32 s4, 3
  s_cbranch_scc1 L_pad20
L_retack:
  s_mov_b64 exec, -1
  s_waitcnt vmcnt(0)
  s_barrier
  s_cmp_lg_u32 s23, 0
  s_cbranch_scc1 L_sig0
  s_atomic_add s1, s[28:29], 0
  s_atomic_add s1, s[28:29], 1152
  s_atomic_add s1, s[28:29], 2304
  s_atomic_add s1, s[28:29], 3456
  s_atomic_add s1, s[28:29], 4608
  s_atomic_add s1, s[28:29], 5760
  s_atomic_add s1, s[28:29], 6912
  s_atomic_add s1, s[28:29], 8064
L_sig0:
  v_lshrrev_b32_e64 v4, 2, v1
  v_lshl_add_u32 v4, v2, 3, v4
  v_mul_u32_u24 v4, 144, v4
  v_and_b32_e64 v5, 3, v0
  v_lshl_add_u32 v4, v5, 3, v4
  v_add_u32 v27, 114688, v4
  v_lshl_add_u32 v28, s4, 5, v27
  s_waitcnt vmcnt(0)
  s_barrier
  ds_read_b128 v[112:115], v8 offset:0
  ds_read_b128 v[116:119], v9 offset:0
  ds_read_b128 v[120:123], v62 offset:0
  ds_read_b128 v[124:127], v63 offset:0
  ds_read_b128 v[128:131], v8 offset:16384
  ds_read_b128 v[132:135], v9 offset:16384
  ds_read_b128 v[136:139], v62 offset:16384
  ds_read_b128 v[140:143], v63 offset:16384
  v_xor_b32 v8, 0x10000, v8
  v_xor_b32 v9, 0x10000, v9
  v_xor_b32 v62, 0x10000, v62
  v_xor_b32 v63, 0x10000, v63
  ds_read_b128 v[144:147], v8 offset:0
  ds_read_b128 v[148:151], v9 offset:0
  ds_read_b128 v[152:155], v62 offset:0
  ds_read_b128 v[156:159], v63 offset:0
  ds_read_b64_tr_b16 v[40:41], v28 offset:0
  ds_read_b64_tr_b16 v[44:45], v27 offset:128
  ds_read_b64_tr_b16 v[42:43], v28 offset:576
  ds_read_b64_tr_b16 v[46:47], v27 offset:704
  v_lshlrev_b32_e64 v5, 4, v1
  v_lshl_add_u32 v26, v2, 7, v5
  s_mul_i32 s90, s81, 18
  s_add_u32 s90, s90, s82
  s_mul_i32 s90, s90, 4608
  s_add_u32 s90, s90, 9437184
  s_add_u32 s91, s90, 4096
  s_lshl_b32 s3, s4, 4
  s_lshl_b64 s[34:35], 0xff, s3
  s_waitcnt lgkmcnt(0)
  s_cmp_lg_u32 s4, 0
  s_cbranch_scc1 L_p07
  s_load_dword s31, s[40:41], s92 glc
L_p07:
  s_barrier
  ds_read_b128 v[160:163], v8 offset:16384
  ds_read_b128 v[164:167], v9 offset:16384
  ds_read_b128 v[168:171], v62 offset:16384
  ds_read_b128 v[172:175], v63 offset:16384
  ds_read_b128 v[176:179], v8 offset:32768
  ds_read_b128 v[180:183], v9 offset:32768
  ds_read_b128 v[184:187], v62 offset:32768
  ds_read_b128 v[188:191], v63 offset:32768
  s_add_u32 s3, s84, 102400
  v_add_u32 v68, s3, v3
  v_mul_u32_u24 v5, 294912, v2
  v_lshl_add_u32 v67, v1, 4, v5
  v_lshl_add_u32 v4, s4, 4, v1
  v_mov_b32 v5, 2147483632
  v_cmp_lt_u32_e64 vcc, 35, v4
  s_mul_i32 s21, s5, 576
  s_mul_i32 s3, s6, 36
  v_cndmask_b32 v67, v67, v5, vcc
  s_add_u32 s21, s21, s3
  s_lshl_b32 s3, s4, 4
  s_add_u32 s21, s21, s3
  s_lshl_b32 s21, s21, 4
  s_add_u32 s21, s21, 3145728
  s_waitcnt lgkmcnt(0)
  s_cmp_lg_u32 s4, 0
  s_cbranch_scc1 L_c0n
  s_cmp_lt_u32 s31, 27
  s_cbranch_scc0 L_c0n
  s_load_dword s31, s[40:41], s92 glc
L_c0n:
  s_cmp_ge_u32 s82, 18
  s_barrier
  s_cbranch_scc1 L_nows
  buffer_store_dwordx4 v[40:43], v70, s[40:43], s90 offen sc1
  s_mov_b64 exec, s[34:35]
  buffer_store_dwordx4 v[44:47], v26, s[40:43], s91 offen sc1
  s_mov_b64 exec, -1
L_nows:
  s_cmp_lg_u32 s4, 0
  s_cbranch_scc1 L_c0d
  s_mov_b32 s87, 0
  s_branch L_sc10
L_sl8:
  s_load_dword s31, s[40:41], s92 glc
  s_add_u32 s87, s87, 1
  s_cmp_gt_u32 s87, 200000
  s_cbranch_scc1 L_se9
L_sc10:
  s_waitcnt lgkmcnt(0)
  s_cmp_lt_u32 s31, 27
  s_cbranch_scc1 L_sl8
L_se9:
  s_waitcnt lgkmcnt(0)
  s_mov_b32 m0, 65536
  s_nop 0
  buffer_load_dwordx4 v3, s[40:43], s65 offen offset:0 sc1 lds
  buffer_load_dwordx4 v3, s[40:43], s65 offen offset:1024 sc1 lds
  buffer_load_dwordx4 v3, s[40:43], s65 offen offset:2048 sc1 lds
  buffer_load_dwordx4 v3, s[40:43], s65 offen offset:3072 sc1 lds
  s_mov_b32 m0, 102400
  s_mov_b32 exec_hi, 0xffff
  buffer_load_dwordx4 v11, s[40:43], s65 offen offset:0 sc1 lds
  buffer_load_dwordx4 v11, s[40:43], s65 offen offset:1024 sc1 lds
  s_mov_b32 exec_hi, -1
  s_mov_b32 m0, 69632
  s_nop 0
  buffer_load_dwordx4 v3, s[40:43], s66 offen offset:0 sc1 lds
  buffer_load_dwordx4 v3, s[40:43], s66 offen offset:1024 sc1 lds
  buffer_load_dwordx4 v3, s[40:43], s66 offen offset:2048 sc1 lds
  buffer_load_dwordx4 v3, s[40:43], s66 offen offset:3072 sc1 lds
  s_mov_b32 m0, 104448
  s_mov_b32 exec_hi, 0xffff
  buffer_load_dwordx4 v11, s[40:43], s66 offen offset:0 sc1 lds
  buffer_load_dwordx4 v11, s[40:43], s66 offen offset:1024 sc1 lds
  s_mov_b32 exec_hi, -1
  s_mov_b32 m0, 73728
  s_nop 0
  buffer_load_dwordx4 v3, s[40:43], s67 offen offset:0 sc1 lds
  buffer_load_dwordx4 v3, s[40:43], s67 offen offset:1024 sc1 lds
  buffer_load_dwordx4 v3, s[40:43], s67 offen offset:2048 sc1 lds
  buffer_load_dwordx4 v3, s[40:43], s67 offen offset:3072 sc1 lds
  s_mov_b32 m0, 106496
  s_mov_b32 exec_hi, 0xffff
  buffer_load_dwordx4 v11, s[40:43], s67 offen offset:0 sc1 lds
  buffer_load_dwordx4 v11, s[40:43], s67 offen offset:1024 sc1 lds
  s_mov_b32 exec_hi, -1
L_c0d:
  v_xor_b32 v8, 0x10000, v8
  v_xor_b32 v9, 0x10000, v9
  v_xor_b32 v62, 0x10000, v62
  v_xor_b32 v63, 0x10000, v63
  ds_read_b128 v[192:195], v8 offset:32768
L_pad5:
  ds_read_b128 v[196:199], v9 offset:32768
  ds_read_b128 v[200:203], v62 offset:32768
  ds_read_b128 v[204:207], v63 offset:32768
  ds_read_b128 v[208:211], v8 offset:49152
  ds_read_b128 v[212:215], v9 offset:49152
  ds_read_b128 v[216:219], v62 offset:49152
  ds_read_b128 v[220:223], v63 offset:49152
  s_barrier
  s_add_u32 m0, s84, 77824
  s_nop 0
  buffer_load_dwordx4 v70, s[40:43], s68 offen sc1 lds
  s_add_u32 m0, s85, 108544
  s_mov_b64 exec, s[44:45]
  buffer_load_dwordx4 v11, s[40:43], s68 offen sc1 lds
  s_mov_b64 exec, -1
  ds_read_b128 v[224:227], v8 offset:0
  ds_read_b128 v[228:231], v9 offset:0
  ds_read_b128 v[232:235], v62 offset:0
  ds_read_b128 v[236:239], v63 offset:0
  ds_read_b128 v[240:243], v8 offset:16384
  ds_read_b128 v[244:247], v9 offset:16384
  ds_read_b128 v[248:251], v62 offset:16384
  ds_read_b128 v[252:255], v63 offset:16384
  s_add_u32 m0, s84, 81920
  s_nop 0
  buffer_load_dwordx4 v70, s[40:43], s69 offen sc1 lds
  s_add_u32 m0, s85, 110592
  s_mov_b64 exec, s[44:45]
  buffer_load_dwordx4 v11, s[40:43], s69 offen sc1 lds
  s_mov_b64 exec, -1
  s_add_u32 m0, s84, 86016
  s_nop 0
  buffer_load_dwordx4 v70, s[40:43], s70 offen sc1 lds
  s_add_u32 m0, s85, 112640
  s_mov_b64 exec, s[44:45]
  buffer_load_dwordx4 v11, s[40:43], s70 offen sc1 lds
  s_mov_b64 exec, -1
  s_waitcnt lgkmcnt(0)
  s_waitcnt vmcnt(6)
  s_barrier
  s_cmp_lg_u32 s4, 1
  s_cbranch_scc1 L_sigw
  s_cmp_ge_u32 s82, 18
  s_cbranch_scc1 L_sigw
  s_atomic_add s1, s[28:29], 12
  s_atomic_add s1, s[28:29], 1164
  s_atomic_add s1, s[28:29], 2316
  s_atomic_add s1, s[28:29], 3468
  s_atomic_add s1, s[28:29], 4620
  s_atomic_add s1, s[28:29], 5772
  s_atomic_add s1, s[28:29], 6924
  s_atomic_add s1, s[28:29], 8076
L_sigw:
  s_add_u32 m0, s84, 90112
  s_nop 0
  buffer_load_dwordx4 v70, s[40:43], s71 offen sc1 lds
  s_add_u32 m0, s85, 114688
  s_mov_b64 exec, s[44:45]
  buffer_load_dwordx4 v11, s[40:43], s71 offen sc1 lds
  s_mov_b64 exec, -1
  s_add_u32 m0, s84, 94208
  s_nop 0
  buffer_load_dwordx4 v70, s[40:43], s72 offen sc1 lds
  s_add_u32 m0, s85, 116736
  s_mov_b64 exec, s[44:45]
  buffer_load_dwordx4 v11, s[40:43], s72 offen sc1 lds
  s_mov_b64 exec, -1
  s_add_u32 m0, s84, 98304
  s_nop 0
  buffer_load_dwordx4 v70, s[40:43], s73 offen sc1 lds
  s_add_u32 m0, s85, 118784
  s_mov_b64 exec, s[44:45]
  buffer_load_dwordx4 v11, s[40:43], s73 offen sc1 lds
  s_mov_b64 exec, -1
  s_waitcnt vmcnt(10)
  s_barrier
  s_add_u32 m0, s84, 0
  s_nop 0
  buffer_load_dwordx4 v10, s[40:43], s65 offen sc1 lds
  s_add_u32 m0, s84, 4096
  s_nop 0
  buffer_load_dwordx4 v10, s[40:43], s66 offen sc1 lds
  s_add_u32 m0, s84, 8192
  s_nop 0
  buffer_load_dwordx4 v10, s[40:43], s67 offen sc1 lds
  s_waitcnt vmcnt(9)
  s_barrier
  s_add_u32 m0, s84, 12288
  s_nop 0
  buffer_load_dwordx4 v10, s[40:43], s68 offen sc1 lds
  s_add_u32 m0, s84, 16384
  s_nop 0
  buffer_load_dwordx4 v10, s[40:43], s69 offen sc1 lds
  s_add_u32 m0, s84, 20480
  s_nop 0
  buffer_load_dwordx4 v10, s[40:43], s70 offen sc1 lds
  s_add_u32 m0, s84, 24576
  s_nop 0
  buffer_load_dwordx4 v10, s[40:43], s71 offen sc1 lds
  s_waitcnt vmcnt(7)
  s_mov_b64 exec, 0
  s_cmp_eq_u32 s4, 1
  s_cbranch_scc1 L_pad8
L_retk3:
  s_mov_b64 exec, -1
  s_barrier
  s_add_u32 m0, s84, 28672
  s_nop 0
  buffer_load_dwordx4 v10, s[40:43], s72 offen sc1 lds
  s_add_u32 m0, s84, 32768
  s_nop 0
  buffer_load_dwordx4 v10, s[40:43], s73 offen sc1 lds
  s_cmp_eq_u32 s4, 1
  s_cselect_b32 s3, s75, s46
  s_add_u32 s28, s40, s3
  s_addc_u32 s29, s41, 0
  s_mov_b32 s31, 0
  s_add_u32 m0, s84, 120832
  s_nop 0
  buffer_load_dwordx4 v12, s[40:43], s65 offen sc1 lds
  s_add_u32 m0, s84, 124928
  s_nop 0
  buffer_load_dwordx4 v12, s[40:43], s66 offen sc1 lds
  s_add_u32 m0, s84, 129024
  s_nop 0
  buffer_load_dwordx4 v12, s[40:43], s67 offen sc1 lds
  s_add_u32 m0, s84, 133120
  s_nop 0
  buffer_load_dwordx4 v12, s[40:43], s68 offen sc1 lds
  s_add_u32 m0, s84, 137216
  s_nop 0
  buffer_load_dwordx4 v12, s[40:43], s69 offen sc1 lds
  s_add_u32 m0, s84, 141312
  s_nop 0
  buffer_load_dwordx4 v12, s[40:43], s70 offen sc1 lds
  s_add_u32 m0, s84, 145408
  s_nop 0
  buffer_load_dwordx4 v12, s[40:43], s71 offen sc1 lds
  s_add_u32 m0, s84, 149504
  s_nop 0
  buffer_load_dwordx4 v12, s[40:43], s72 offen sc1 lds
  s_waitcnt vmcnt(8)
  s_barrier
  ds_read_b128 v[40:43], v83 offset:0
  ds_read_b128 v[44:47], v83 offset:512
  ds_read_b128 v[48:51], v83 offset:2048
  ds_read_b128 v[52:55], v83 offset:2560
  s_waitcnt lgkmcnt(3)
  v_mfma_f32_32x32x16_bf16 v[16:31], v[112:115], v[40:43], 0
  ds_read_b128 v[56:59], v83 offset:4096
  s_add_u32 m0, s84, 153600
  s_nop 0
  buffer_load_dwordx4 v12, s[40:43], s73 offen sc1 lds
  s_waitcnt lgkmcnt(3)
  v_mfma_f32_32x32x16_bf16 v[16:31], v[116:119], v[44:47], v[16:31]
  ds_read_b128 v[40:43], v83 offset:4608
  s_waitcnt lgkmcnt(3)
  v_mfma_f32_32x32x16_bf16 v[16:31], v[120:123], v[48:51], v[16:31]
  ds_read_b128 v[44:47], v83 offset:6144
  s_waitcnt lgkmcnt(3)
  v_mfma_f32_32x32x16_bf16 v[16:31], v[124:127], v[52:55], v[16:31]
  ds_read_b128 v[48:51], v83 offset:6656
  s_waitcnt lgkmcnt(3)
  v_mfma_f32_32x32x16_bf16 v[16:31], v[128:131], v[56:59], v[16:31]
L_pad6:
  ds_read_b128 v[52:55], v83 offset:8192
  s_mov_b32 exec_hi, 0xffff
  buffer_store_dwordx4 v[84:87], v3, s[40:43], s17 offen sc1
  s_mov_b32 exec_hi, -1
  s_waitcnt lgkmcnt(3)
  v_mfma_f32_32x32x16_bf16 v[16:31], v[132:135], v[40:43], v[16:31]
  ds_read_b128 v[56:59], v83 offset:8704
  s_waitcnt lgkmcnt(3)
  v_mfma_f32_32x32x16_bf16 v[16:31], v[136:139], v[44:47], v[16:31]
  ds_read_b128 v[40:43], v83 offset:10240
  buffer_store_dwordx4 v[84:87], v3, s[40:43], s18 offen sc1
  s_waitcnt lgkmcnt(3)
  v_mfma_f32_32x32x16_bf16 v[16:31], v[140:143], v[48:51], v[16:31]
  ds_read_b128 v[44:47], v83 offset:10752
  s_waitcnt lgkmcnt(3)
  v_mfma_f32_32x32x16_bf16 v[16:31], v[144:147], v[52:55], v[16:31]
  ds_read_b128 v[48:51], v83 offset:12288
  buffer_store_dwordx4 v[84:87], v3, s[40:43], s19 offen sc1
  s_waitcnt lgkmcnt(3)
  v_mfma_f32_32x32x16_bf16 v[16:31], v[148:151], v[56:59], v[16:31]
  ds_read_b128 v[52:55], v83 offset:12800
  s_waitcnt lgkmcnt(3)
  v_mfma_f32_32x32x16_bf16 v[16:31], v[152:155], v[40:43], v[16:31]
  ds_read_b128 v[56:59], v83 offset:14336
  buffer_store_dword v84, v82, s[40:43], s20 offen sc1
  s_waitcnt lgkmcnt(3)
  v_mfma_f32_32x32x16_bf16 v[16:31], v[156:159], v[44:47], v[16:31]
  ds_read_b128 v[40:43], v83 offset:14848
  s_waitcnt lgkmcnt(3)
  v_mfma_f32_32x32x16_bf16 v[16:31], v[160:163], v[48:51], v[16:31]
  ds_read_b128 v[44:47], v83 offset:16384
  s_waitcnt lgkmcnt(3)
  v_mfma_f32_32x32x16_bf16 v[16:31], v[164:167], v[52:55], v[16:31]
  ds_read_b128 v[48:51], v83 offset:16896
  s_waitcnt lgkmcnt(3)
  v_mfma_f32_32x32x16_bf16 v[16:31], v[168:171], v[56:59], v[16:31]
  ds_read_b128 v[52:55], v83 offset:18432
  s_waitcnt lgkmcnt(3)
  v_mfma_f32_32x32x16_bf16 v[16:31], v[172:175], v[40:43], v[16:31]
  ds_read_b128 v[56:59], v83 offset:18944
  s_waitcnt lgkmcnt(3)
  v_mfma_f32_32x32x16_bf16 v[16:31], v[176:179], v[44:47], v[16:31]
  ds_read_b128 v[40:43], v83 offset:20480
  s_waitcnt lgkmcnt(3)
  v_mfma_f32_32x32x16_bf16 v[16:31], v[180:183], v[48:51], v[16:31]
  ds_read_b128 v[44:47], v83 offset:20992
  s_waitcnt lgkmcnt(3)
  v_mfma_f32_32x32x16_bf16 v[16:31], v[184:187], v[52:55], v[16:31]
  ds_read_b128 v[48:51], v83 offset:22528
  s_waitcnt lgkmcnt(3)
  v_mfma_f32_32x32x16_bf16 v[16:31], v[188:191], v[56:59], v[16:31]
  ds_read_b128 v[52:55], v83 offset:23040
  s_waitcnt lgkmcnt(3)
  v_mfma_f32_32x32x16_bf16 v[16:31], v[192:195], v[40:43], v[16:31]
  ds_read_b128 v[56:59], v83 offset:24576
  s_waitcnt lgkmcnt(3)
  v_mfma_f32_32x32x16_bf16 v[16:31], v[196:199], v[44:47], v[16:31]
  ds_read_b128 v[40:43], v83 offset:25088
  s_waitcnt lgkmcnt(3)
  v_mfma_f32_32x32x16_bf16 v[16:31], v[200:203], v[48:51], v[16:31]
  ds_read_b128 v[44:47], v83 offset:26624
  s_waitcnt lgkmcnt(3)
  v_mfma_f32_32x32x16_bf16 v[16:31], v[204:207], v[52:55], v[16:31]
  ds_read_b128 v[48:51], v83 offset:27136
  s_waitcnt lgkmcnt(3)
  v_mfma_f32_32x32x16_bf16 v[16:31], v[208:211], v[56:59], v[16:31]
  ds_read_b128 v[52:55], v83 offset:28672
  s_waitcnt lgkmcnt(3)
  v_mfma_f32_32x32x16_bf16 v[16:31], v[212:215], v[40:43], v[16:31]
  ds_read_b128 v[56:59], v83 offset:29184
  s_waitcnt lgkmcnt(3)
  v_mfma_f32_32x32x16_bf16 v[16:31], v[216:219], v[44:47], v[16:31]
  ds_read_b128 v[40:43], v83 offset:30720
  s_barrier
  s_waitcnt lgkmcnt(3)
  v_mfma_f32_32x32x16_bf16 v[16:31], v[220:223], v[48:51], v[16:31]
  ds_read_b128 v[44:47], v83 offset:31232
  s_mov_b32 s3, 32768
  buffer_load_dwordx4 v[160:163], v70, s[24:27], s3 offen sc1
  s_waitcnt lgkmcnt(3)
  v_mfma_f32_32x32x16_bf16 v[16:31], v[224:227], v[52:55], v[16:31]
  ds_read_b128 v[48:51], v83 offset:32768
  s_mov_b32 s3, 36864
  buffer_load_dwordx4 v[164:167], v70, s[24:27], s3 offen sc1
  s_waitcnt lgkmcnt(3)
  v_mfma_f32_32x32x16_bf16 v[16:31], v[228:231], v[56:59], v[16:31]
  ds_read_b128 v[52:55], v83 offset:33280
  s_mov_b32 s3, 40960
  buffer_load_dwordx4 v[168:171], v70, s[24:27], s3 offen sc1
  s_waitcnt lgkmcnt(3)
  v_mfma_f32_32x32x16_bf16 v[16:31], v[232:235], v[40:43], v[16:31]
  ds_read_b128 v[56:59], v83 offset:34816
  s_mov_b32 s3, 45056
  buffer_load_dwordx4 v[172:175], v70, s[24:27], s3 offen sc1
  s_waitcnt lgkmcnt(3)
  v_mfma_f32_32x32x16_bf16 v[16:31], v[236:239], v[44:47], v[16:31]
  ds_read_b128 v[40:43], v83 offset:35328
  s_mov_b32 s3, 49152
  buffer_load_dwordx4 v[176:179], v70, s[24:27], s3 offen sc1
  s_waitcnt lgkmcnt(3)
  v_mfma_f32_32x32x16_bf16 v[16:31], v[240:243], v[48:51], v[16:31]
  ds_read_b128 v[112:115], v68 offset:0
  s_mov_b32 s3, 53248
  buffer_load_dwordx4 v[180:183], v70, s[24:27], s3 offen sc1
  s_waitcnt lgkmcnt(3)
  v_mfma_f32_32x32x16_bf16 v[16:31], v[244:247], v[52:55], v[16:31]
  ds_read_b128 v[116:119], v68 offset:3072
  s_mov_b32 s3, 57344
  buffer_load_dwordx4 v[184:187], v70, s[24:27], s3 offen sc1
  s_waitcnt lgkmcnt(3)
  v_mfma_f32_32x32x16_bf16 v[16:31], v[248:251], v[56:59], v[16:31]
  ds_read_b128 v[120:123], v68 offset:6144
  s_mov_b32 s3, 61440
  buffer_load_dwordx4 v[188:191], v70, s[24:27], s3 offen sc1
  s_waitcnt lgkmcnt(3)
  v_mfma_f32_32x32x16_bf16 v[16:31], v[252:255], v[40:43], v[16:31]
  ds_read_b128 v[124:127], v68 offset:9216
  s_waitcnt lgkmcnt(0)
  s_cmp_eq_u32 s4, 3
  s_cbranch_scc1 L_nogj
  v_mfma_f32_16x16x32_bf16 v[128:131], v[88:91], v[112:115], 0
  v_mfma_f32_16x16x32_bf16 v[132:135], v[88:91], v[116:119], 0
  v_mfma_f32_16x16x32_bf16 v[136:139], v[88:91], v[120:123], 0
  v_mfma_f32_16x16x32_bf16 v[140:143], v[88:91], v[124:127], 0
  v_mfma_f32_16x16x32_bf16 v[144:147], v[92:95], v[112:115], 0
  v_mfma_f32_16x16x32_bf16 v[148:151], v[92:95], v[116:119], 0
  v_mfma_f32_16x16x32_bf16 v[152:155], v[92:95], v[120:123], 0
  v_mfma_f32_16x16x32_bf16 v[156:159], v[92:95], v[124:127], 0
  s_nop 1
  s_branch L_gj
L_nogj:
  s_nop 11
L_gj:
  v_cvt_pk_bf16_f32 v32, v16, v17
  v_cvt_pk_bf16_f32 v33, v18, v19
  v_cvt_pk_bf16_f32 v34, v24, v25
  v_cvt_pk_bf16_f32 v35, v26, v27
  ds_write_b128 v14, v[32:35] offset:0
  v_cvt_pk_bf16_f32 v36, v20, v21
  v_cvt_pk_bf16_f32 v37, v22, v23
  v_cvt_pk_bf16_f32 v38, v28, v29
  v_cvt_pk_bf16_f32 v39, v30, v31
  ds_write_b128 v14, v[36:39] offset:512
  v_cvt_pk_bf16_f32 v112, v128, v132
  v_cvt_pk_bf16_f32 v113, v136, v140
  v_cvt_pk_bf16_f32 v114, v129, v133
  v_cvt_pk_bf16_f32 v115, v137, v141
  s_add_u32 s3, s21, 0
  buffer_store_dwordx4 v[112:115], v67, s[40:43], s3 offen sc1
  v_cvt_pk_bf16_f32 v116, v130, v134
L_pad7:
  v_cvt_pk_bf16_f32 v117, v138, v142
  v_cvt_pk_bf16_f32 v118, v131, v135
  v_cvt_pk_bf16_f32 v119, v139, v143
  s_add_u32 s3, s21, 147456
  buffer_store_dwordx4 v[116:119], v67, s[40:43], s3 offen sc1
  v_cvt_pk_bf16_f32 v120, v144, v148
  v_cvt_pk_bf16_f32 v121, v152, v156
  v_cvt_pk_bf16_f32 v122, v145, v149
  v_cvt_pk_bf16_f32 v123, v153, v157
  s_add_u32 s3, s21, 1179648
  buffer_store_dwordx4 v[120:123], v67, s[40:43], s3 offen sc1
  v_cvt_pk_bf16_f32 v124, v146, v150
  v_cvt_pk_bf16_f32 v125, v154, v158
  v_cvt_pk_bf16_f32 v126, v147, v151
  v_cvt_pk_bf16_f32 v127, v155, v159
  s_add_u32 s3, s21, 1327104
  buffer_store_dwordx4 v[124:127], v67, s[40:43], s3 offen sc1
  s_waitcnt vmcnt(15)
  s_waitcnt lgkmcnt(0)
  s_barrier
  s_setprio 2
  s_cmp_ge_u32 s4, 2
  s_cbranch_scc1 L_nx
  ds_read_b128 v[52:55], v66 offset:0
  ds_read_b64_tr_b16 v[40:41], v64 offset:0
  ds_read_b64_tr_b16 v[42:43], v64 offset:2560
  ds_read_b64_tr_b16 v[44:45], v64 offset:32
  ds_read_b64_tr_b16 v[46:47], v64 offset:2592
  ds_read_b64_tr_b16 v[48:49], v65 offset:0
  ds_read_b64_tr_b16 v[50:51], v65 offset:2560
  ds_read_b128 v[208:211], v66 offset:2048
  ds_read_b64_tr_b16 v[196:197], v64 offset:5120
  ds_read_b64_tr_b16 v[198:199], v64 offset:7680
  ds_read_b64_tr_b16 v[200:201], v64 offset:5152
  ds_read_b64_tr_b16 v[202:203], v64 offset:7712
  ds_read_b64_tr_b16 v[204:205], v65 offset:5120
  ds_read_b64_tr_b16 v[206:207], v65 offset:7680
  s_waitcnt lgkmcnt(7)
  v_mfma_f32_16x16x32_bf16 v[16:19], v[40:43], v[52:55], 0
  v_mfma_f32_16x16x32_bf16 v[20:23], v[44:47], v[52:55], 0
  v_mfma_f32_16x16x32_bf16 v[24:27], v[48:51], v[52:55], 0
  ds_read_b128 v[224:227], v66 offset:4096
  ds_read_b64_tr_b16 v[212:213], v64 offset:10240
  ds_read_b64_tr_b16 v[214:215], v64 offset:12800
  ds_read_b64_tr_b16 v[216:217], v64 offset:10272
  ds_read_b64_tr_b16 v[218:219], v64 offset:12832
  ds_read_b64_tr_b16 v[220:221], v65 offset:10240
  ds_read_b64_tr_b16 v[222:223], v65 offset:12800
  s_waitcnt lgkmcnt(7)
  v_mfma_f32_16x16x32_bf16 v[16:19], v[196:199], v[208:211], v[16:19]
  v_mfma_f32_16x16x32_bf16 v[20:23], v[200:203], v[208:211], v[20:23]
  v_mfma_f32_16x16x32_bf16 v[24:27], v[204:207], v[208:211], v[24:27]
  ds_read_b128 v[240:243], v66 offset:6144
  ds_read_b64_tr_b16 v[228:229], v64 offset:15360
  ds_read_b64_tr_b16 v[230:231], v64 offset:17920
  ds_read_b64_tr_b16 v[232:233], v64 offset:15392
  ds_read_b64_tr_b16 v[234:235], v64 offset:17952
  ds_read_b64_tr_b16 v[236:237], v65 offset:15360
  ds_read_b64_tr_b16 v[238:239], v65 offset:17920
  s_waitcnt lgkmcnt(7)
  v_mfma_f32_16x16x32_bf16 v[16:19], v[212:215], v[224:227], v[16:19]
  v_mfma_f32_16x16x32_bf16 v[20:23], v[216:219], v[224:227], v[20:23]
  v_mfma_f32_16x16x32_bf16 v[24:27], v[220:223], v[224:227], v[24:27]
  s_waitcnt lgkmcnt(0)
  v_mfma_f32_16x16x32_bf16 v[16:19], v[228:231], v[240:243], v[16:19]
  v_mfma_f32_16x16x32_bf16 v[20:23], v[232:235], v[240:243], v[20:23]
  v_mfma_f32_16x16x32_bf16 v[24:27], v[236:239], v[240:243], v[24:27]
  s_mov_b32 s90, -1
  s_mov_b32 s3, 0xffff
  s_branch L_kvd
L_nx:
  ds_read_b64_tr_b16 v[52:53], v65 offset:8
  ds_read_b64_tr_b16 v[54:55], v65 offset:2568
  ds_read_b64_tr_b16 v[40:41], v64 offset:0
  ds_read_b64_tr_b16 v[42:43], v64 offset:2560
  ds_read_b64_tr_b16 v[44:45], v64 offset:32
  ds_read_b64_tr_b16 v[46:47], v64 offset:2592
  ds_read_b64_tr_b16 v[48:49], v65 offset:0
  ds_read_b64_tr_b16 v[50:51], v65 offset:2560
  ds_read_b64_tr_b16 v[208:209], v65 offset:5128
  ds_read_b64_tr_b16 v[210:211], v65 offset:7688
  ds_read_b64_tr_b16 v[196:197], v64 offset:5120
  ds_read_b64_tr_b16 v[198:199], v64 offset:7680
  ds_read_b64_tr_b16 v[200:201], v64 offset:5152
  ds_read_b64_tr_b16 v[202:203], v64 offset:7712
  ds_read_b64_tr_b16 v[204:205], v65 offset:5120
  ds_read_b64_tr_b16 v[206:207], v65 offset:7680
  s_waitcnt lgkmcnt(8)
  v_mfma_f32_16x16x32_bf16 v[16:19], v[40:43], v[52:55], 0
  v_mfma_f32_16x16x32_bf16 v[20:23], v[44:47], v[52:55], 0
  v_mfma_f32_16x16x32_bf16 v[24:27], v[48:51], v[52:55], 0
  ds_read_b64_tr_b16 v[224:225], v65 offset:10248
  ds_read_b64_tr_b16 v[226:227], v65 offset:12808
  ds_read_b64_tr_b16 v[212:213], v64 offset:10240
  ds_read_b64_tr_b16 v[214:215], v64 offset:12800
  ds_read_b64_tr_b16 v[216:217], v64 offset:10272
  ds_read_b64_tr_b16 v[218:219], v64 offset:12832
  ds_read_b64_tr_b16 v[220:221], v65 offset:10240
  ds_read_b64_tr_b16 v[222:223], v65 offset:12800
  s_waitcnt lgkmcnt(8)
  v_mfma_f32_16x16x32_bf16 v[16:19], v[196:199], v[208:211], v[16:19]
  v_mfma_f32_16x16x32_bf16 v[20:23], v[200:203], v[208:211], v[20:23]
  v_mfma_f32_16x16x32_bf16 v[24:27], v[204:207], v[208:211], v[24:27]
  ds_read_b64_tr_b16 v[240:241], v65 offset:15368
  ds_read_b64_tr_b16 v[242:243], v65 offset:17928
  ds_read_b64_tr_b16 v[228:229], v64 offset:15360
  ds_read_b64_tr_b16 v[230:231], v64 offset:17920
  ds_read_b64_tr_b16 v[232:233], v64 offset:15392
  ds_read_b64_tr_b16 v[234:235], v64 offset:17952
  ds_read_b64_tr_b16 v[236:237], v65 offset:15360
  ds_read_b64_tr_b16 v[238:239], v65 offset:17920
  s_waitcnt lgkmcnt(8)
  v_mfma_f32_16x16x32_bf16 v[16:19], v[212:215], v[224:227], v[16:19]
  v_mfma_f32_16x16x32_bf16 v[20:23], v[216:219], v[224:227], v[20:23]
  v_mfma_f32_16x16x32_bf16 v[24:27], v[220:223], v[224:227], v[24:27]
  s_waitcnt lgkmcnt(0)
  v_mfma_f32_16x16x32_bf16 v[16:19], v[228:231], v[240:243], v[16:19]
  v_mfma_f32_16x16x32_bf16 v[20:23], v[232:235], v[240:243], v[20:23]
  v_mfma_f32_16x16x32_bf16 v[24:27], v[236:239], v[240:243], v[24:27]
  s_mov_b32 s90, 0x000f000f
  s_mov_b32 s3, 15
L_kvd:
  s_nop 4
  v_cvt_pk_bf16_f32 v28, v16, v17
  v_cvt_pk_bf16_f32 v29, v18, v19
  v_cvt_pk_bf16_f32 v30, v20, v21
  v_cvt_pk_bf16_f32 v31, v22, v23
  v_cvt_pk_bf16_f32 v32, v24, v25
  v_cvt_pk_bf16_f32 v33, v26, v27
  s_mov_b32 exec_lo, s90
  s_mov_b32 exec_hi, s90
  buffer_store_dwordx4 v[28:31], v69, s[40:43], s86 offen sc1
  s_mov_b32 exec_lo, s3
  s_mov_b32 exec_hi, 0
  buffer_store_dwordx2 v[32:33], v71, s[40:43], s86 offen offset:1280 sc1
  s_mov_b64 exec, -1
  s_cmp_lg_u32 s4, 3
  s_cbranch_scc1 L_sig1
  s_atomic_add s1, s[28:29], 0
  s_atomic_add s1, s[28:29], 1152
  s_atomic_add s1, s[28:29], 2304
  s_atomic_add s1, s[28:29], 3456
L_sig1:
L_pad8:
  s_cbranch_execz L_retk3
  s_setprio 0
  s_add_u32 m0, s84, 12288
  s_add_u32 s3, s84, 12288
  buffer_load_dwordx4 v3, s[24:27], s3 offen sc1 lds
  s_add_u32 m0, s84, 16384
  s_add_u32 s3, s84, 16384
  buffer_load_dwordx4 v3, s[24:27], s3 offen sc1 lds
  s_add_u32 m0, s84, 20480
  s_add_u32 s3, s84, 20480
  buffer_load_dwordx4 v3, s[24:27], s3 offen sc1 lds
  s_add_u32 m0, s84, 24576
  s_add_u32 s3, s84, 24576
  buffer_load_dwordx4 v3, s[24:27], s3 offen sc1 lds
  s_add_u32 m0, s84, 28672
  s_add_u32 s3, s84, 28672
  buffer_load_dwordx4 v3, s[24:27], s3 offen sc1 lds
  s_add_u32 m0, s84, 65536
  s_add_u32 s3, s84, 65536
  buffer_load_dwordx4 v3, s[24:27], s3 offen sc1 lds
  s_add_u32 m0, s84, 69632
  s_add_u32 s3, s84, 69632
  buffer_load_dwordx4 v3, s[24:27], s3 offen sc1 lds
  s_cmp_lg_u32 s4, 3
  s_cbranch_scc1 L_c1a
  s_load_dword s31, s[40:41], s30 glc
L_c1a:
  s_waitcnt vmcnt(9)
  s_barrier
  s_cmp_lg_u32 s4, 1
  s_cbranch_scc1 L_sigg
  s_atomic_add s1, s[28:29], 0
  s_atomic_add s1, s[28:29], 640
  s_atomic_add s1, s[28:29], 1280
  s_atomic_add s1, s[28:29], 1920
  s_atomic_add s1, s[28:29], 2560
  s_atomic_add s1, s[28:29], 3200
  s_atomic_add s1, s[28:29], 3840
  s_atomic_add s1, s[28:29], 4480
L_sigg:
  s_setprio 2
  s_mov_b64 exec, 0
  s_cmp_eq_u32 s4, 0
  s_cbranch_scc1 L_pad12
L_retwo1:
  s_mov_b64 exec, -1
  s_cmp_lg_u32 s4, 3
  s_cbranch_scc1 L_c1
  s_mov_b32 s87, 0
  s_branch L_sc13
L_sl11:
  s_load_dword s31, s[40:41], s30 glc
  s_add_u32 s87, s87, 1
  s_cmp_gt_u32 s87, 200000
  s_cbranch_scc1 L_se12
L_sc13:
  s_waitcnt lgkmcnt(0)
  s_cmp_lt_u32 s31, 16
  s_cbranch_scc1 L_sl11
L_se12:
  s_waitcnt lgkmcnt(0)
L_c1:
  s_barrier
  buffer_load_dwordx4 v[196:199], v76, s[40:43], s56 offen offset:0 sc1
  buffer_load_dwordx4 v[200:203], v76, s[40:43], s56 offen offset:256 sc1
  buffer_load_dwordx4 v[204:207], v78, s[40:43], s56 offen offset:512 sc1
  buffer_load_dwordx4 v[208:211], v76, s[40:43], s57 offen offset:0 sc1
  buffer_load_dwordx4 v[212:215], v76, s[40:43], s57 offen offset:256 sc1
  buffer_load_dwordx4 v[216:219], v78, s[40:43], s57 offen offset:512 sc1
  buffer_load_dwordx4 v[220:223], v76, s[40:43], s58 offen offset:0 sc1
  buffer_load_dwordx4 v[224:227], v76, s[40:43], s58 offen offset:256 sc1
  buffer_load_dwordx4 v[228:231], v78, s[40:43], s58 offen offset:512 sc1
  buffer_load_dwordx4 v[232:235], v76, s[40:43], s59 offen offset:0 sc1
  buffer_load_dwordx4 v[236:239], v76, s[40:43], s59 offen offset:256 sc1
  buffer_load_dwordx4 v[240:243], v78, s[40:43], s59 offen offset:512 sc1
  s_lshr_b32 s15, s4, 1
  s_lshl_b32 s15, s15, 5
  s_add_u32 s15, s15, s14
  s_and_b32 s16, s4, 1
  s_lshl_b32 s17, s16, 10
  s_add_u32 s17, s17, s15
  v_lshl_add_u32 v24, v1, 6, s17
  v_cvt_f32_u32_e64 v24, v24
  v_mul_f32 v24, 0x3a000000, v24
  v_lshlrev_b32 v25, 2, v2
  v_cvt_f32_u32 v25, v25
  v_mul_f32 v32, v24, v25
  v_fract_f32 v32, v32
  v_mul_f32 v26, 0x41800000, v24
  v_fract_f32 v26, v26
  v_add_f32 v36, v32, v26
  v_cos_f32_e64 v26, v26
  v_fmamk_f32 v33, v24, 0x3f800000, v32
  v_fmamk_f32 v34, v24, 0x40000000, v32
  v_fmamk_f32 v35, v24, 0x40400000, v32
  v_fmamk_f32 v37, v24, 0x3f800000, v36
  v_fmamk_f32 v38, v24, 0x40000000, v36
  v_fmamk_f32 v39, v24, 0x40400000, v36
  v_add_f32 v26, v26, v26
  v_cos_f32 v48, v32
  v_sin_f32 v32, v32
  v_cos_f32 v49, v33
  v_sin_f32 v33, v33
  v_cos_f32 v50, v34
  v_sin_f32 v34, v34
  v_cos_f32 v51, v35
  v_sin_f32 v35, v35
  v_cos_f32 v52, v36
  v_sin_f32 v36, v36
  v_cos_f32 v53, v37
  v_sin_f32 v37, v37
  v_cos_f32 v54, v38
  v_sin_f32 v38, v38
  v_cos_f32 v55, v39
  v_sin_f32_e64 v39, v39
  v_pk_fma_f32 v[56:57], v[52:53], v[26:27], v[48:49] op_sel_hi:[1,0,1] neg_lo:[0,0,1] neg_hi:[0,0,1]
  v_pk_fma_f32 v[40:41], v[36:37], v[26:27], v[32:33] op_sel_hi:[1,0,1] neg_lo:[0,0,1] neg_hi:[0,0,1]
  v_pk_fma_f32 v[58:59], v[54:55], v[26:27], v[50:51] op_sel_hi:[1,0,1] neg_lo:[0,0,1] neg_hi:[0,0,1]
  v_pk_fma_f32 v[42:43], v[38:39], v[26:27], v[34:35] op_sel_hi:[1,0,1] neg_lo:[0,0,1] neg_hi:[0,0,1]
  v_pk_fma_f32 v[60:61], v[56:57], v[26:27], v[52:53] op_sel_hi:[1,0,1] neg_lo:[0,0,1] neg_hi:[0,0,1]
  v_pk_fma_f32 v[44:45], v[40:41], v[26:27], v[36:37] op_sel_hi:[1,0,1] neg_lo:[0,0,1] neg_hi:[0,0,1]
  v_pk_fma_f32 v[62:63], v[58:59], v[26:27], v[54:55] op_sel_hi:[1,0,1] neg_lo:[0,0,1] neg_hi:[0,0,1]
  v_pk_fma_f32 v[46:47], v[42:43], v[26:27], v[38:39] op_sel_hi:[1,0,1] neg_lo:[0,0,1] neg_hi:[0,0,1]
  v_cvt_pk_bf16_f32 v96, v48, v49
  v_cvt_pk_bf16_f32 v112, v32, v33
  v_cvt_pk_bf16_f32 v97, v50, v51
  v_cvt_pk_bf16_f32 v113, v34, v35
  v_cvt_pk_bf16_f32 v100, v52, v53
  v_cvt_pk_bf16_f32 v116, v36, v37
  v_cvt_pk_bf16_f32 v101, v54, v55
  v_cvt_pk_bf16_f32 v117, v38, v39
  v_cvt_pk_bf16_f32 v104, v56, v57
  v_cvt_pk_bf16_f32 v120, v40, v41
  v_cvt_pk_bf16_f32 v105, v58, v59
  v_cvt_pk_bf16_f32 v121, v42, v43
  v_cvt_pk_bf16_f32 v108, v60, v61
  v_cvt_pk_bf16_f32 v124, v44, v45
  v_cvt_pk_bf16_f32 v109, v62, v63
  v_cvt_pk_bf16_f32 v125, v46, v47
  ds_write_b128 v70, v[160:163] offset:32768
  ds_write_b128 v70, v[164:167] offset:36864
  ds_write_b128 v70, v[168:171] offset:40960
  ds_write_b128 v70, v[172:175] offset:45056
  ds_write_b128 v70, v[176:179] offset:49152
  ds_write_b128 v70, v[180:183] offset:53248
  ds_write_b128 v70, v[184:187] offset:57344
  ds_write_b128 v70, v[188:191] offset:61440
  s_waitcnt vmcnt(6)
  s_load_dword s66, s[40:41], s60
  s_load_dword s67, s[40:41], s61
  s_load_dword s68, s[40:41], s62
  s_load_dword s69, s[40:41], s63
  s_load_dword s70, s[40:41], s64
  s_load_dword s71, s[40:41], s74
  s_mov_b32 s87, 0
L_pred:
  s_waitcnt vmcnt(9)
  v_mfma_f32_16x16x32_bf16 v[244:247], v[72:75], v[196:199], 0
  v_mfma_f32_16x16x32_bf16 v[248:251], v[72:75], v[200:203], 0
  v_mfma_f32_16x16x32_bf16 v[252:255], v[72:75], v[204:207], 0
  s_waitcnt vmcnt(6)
  v_mfma_f32_16x16x32_bf16 v[244:247], v[72:75], v[208:211], v[244:247]
  v_mfma_f32_16x16x32_bf16 v[248:251], v[72:75], v[212:215], v[248:251]
  v_mfma_f32_16x16x32_bf16 v[252:255], v[72:75], v[216:219], v[252:255]
L_pad9:
  s_waitcnt vmcnt(3)
  v_mfma_f32_16x16x32_bf16 v[244:247], v[72:75], v[220:223], v[244:247]
  v_mfma_f32_16x16x32_bf16 v[248:251], v[72:75], v[224:227], v[248:251]
  v_mfma_f32_16x16x32_bf16 v[252:255], v[72:75], v[228:231], v[252:255]
  s_waitcnt vmcnt(0)
  v_mfma_f32_16x16x32_bf16 v[244:247], v[72:75], v[232:235], v[244:247]
  v_mfma_f32_16x16x32_bf16 v[248:251], v[72:75], v[236:239], v[248:251]
  v_mfma_f32_16x16x32_bf16 v[252:255], v[72:75], v[240:243], v[252:255]
  s_nop 6
  v_add_f32 v4, v244, v248
  v_cmp_u_f32_e64 vcc, v4, v252
  s_cbranch_vccz L_pok
  s_add_u32 s87, s87, 1
  s_cmp_gt_u32 s87, 2000
  s_cbranch_scc1 L_pok
  buffer_load_dwordx4 v[196:199], v76, s[40:43], s56 offen offset:0 sc1
  buffer_load_dwordx4 v[200:203], v76, s[40:43], s56 offen offset:256 sc1
  buffer_load_dwordx4 v[204:207], v78, s[40:43], s56 offen offset:512 sc1
  buffer_load_dwordx4 v[208:211], v76, s[40:43], s57 offen offset:0 sc1
  buffer_load_dwordx4 v[212:215], v76, s[40:43], s57 offen offset:256 sc1
  buffer_load_dwordx4 v[216:219], v78, s[40:43], s57 offen offset:512 sc1
  buffer_load_dwordx4 v[220:223], v76, s[40:43], s58 offen offset:0 sc1
  buffer_load_dwordx4 v[224:227], v76, s[40:43], s58 offen offset:256 sc1
  buffer_load_dwordx4 v[228:231], v78, s[40:43], s58 offen offset:512 sc1
  buffer_load_dwordx4 v[232:235], v76, s[40:43], s59 offen offset:0 sc1
  buffer_load_dwordx4 v[236:239], v76, s[40:43], s59 offen offset:256 sc1
  buffer_load_dwordx4 v[240:243], v78, s[40:43], s59 offen offset:512 sc1
  s_branch L_pred
L_pok:
  v_cvt_pk_bf16_f32 v244, v244, v245
  v_cvt_pk_bf16_f32 v245, v246, v247
  ds_write_b64 v77, v[244:245] offset:0
  v_cvt_pk_bf16_f32 v248, v248, v249
  v_cvt_pk_bf16_f32 v249, v250, v251
  ds_write_b64 v77, v[248:249] offset:256
  v_cvt_pk_bf16_f32 v252, v252, v253
  v_cvt_pk_bf16_f32 v253, v254, v255
  ds_write_b64 v77, v[252:253] offset:512
  s_waitcnt lgkmcnt(0)
  s_barrier
  s_setprio 0
  v_mov_b32 v4, 163776
  v_mov_b32_e64 v5, 4
  s_mov_b32 s87, 0
  s_cmp_lg_u32 s4, 0
  s_cbranch_scc1 L_cgo
  s_branch L_cgc
L_cgl:
  s_sleep 4
  s_load_dword s66, s[40:41], s60 glc
  s_load_dword s67, s[40:41], s61 glc
  s_load_dword s68, s[40:41], s62 glc
  s_load_dword s69, s[40:41], s63 glc
  s_load_dword s70, s[40:41], s64 glc
  s_load_dword s71, s[40:41], s74 glc
  s_add_u32 s87, s87, 1
  s_cmp_gt_u32 s87, 200000
  s_cbranch_scc1 L_cge
L_cgc:
  s_waitcnt lgkmcnt(0)
  s_min_u32 s3, s66, s67
  s_min_u32 s3, s3, s68
  s_min_u32 s3, s3, s69
  s_min_u32 s3, s3, s70
  s_min_u32 s3, s3, s71
  s_cmp_lt_u32 s3, 16
  s_cbranch_scc1 L_cgl
L_cge:
  s_waitcnt lgkmcnt(0)
  ds_write_b32 v4, v5 offset:32
  s_branch L_cgd
L_cgo:
  s_waitcnt lgkmcnt(0)
  s_min_u32 s3, s66, s67
  s_min_u32 s3, s3, s68
  s_min_u32 s3, s3, s69
  s_min_u32 s3, s3, s70
  s_min_u32 s3, s3, s71
  s_cmp_lt_u32 s3, 16
  s_cbranch_scc0 L_cgd
  s_mov_b32 s87, 0
L_lw14:
  ds_read_b32 v6, v4 offset:32
  s_add_u32 s87, s87, 1
  s_cmp_gt_u32 s87, 200000
  s_cbranch_scc1 L_le15
  s_waitcnt lgkmcnt(0)
  v_cmp_gt_u32 vcc, 4, v6
  s_cbranch_vccnz L_lw14
L_le15:
  s_waitcnt lgkmcnt(0)
L_cgd:
  s_waitcnt vmcnt(6)
  s_add_u32 m0, s77, 120832
  s_mov_b32 s3, 0
  buffer_load_dwordx4 v79, s[40:43], s3 offen sc1 lds
  s_waitcnt vmcnt(6)
  s_add_u32 m0, s77, 121856
  s_mov_b32 s3, 9216
  buffer_load_dwordx4 v79, s[40:43], s3 offen sc1 lds
  s_waitcnt vmcnt(6)
  s_add_u32 m0, s77, 122880
  s_mov_b32 s3, 18432
  buffer_load_dwordx4 v79, s[40:43], s3 offen sc1 lds
  s_waitcnt vmcnt(6)
  s_add_u32 m0, s77, 123904
  s_mov_b32 s3, 27648
  buffer_load_dwordx4 v79, s[40:43], s3 offen sc1 lds
  s_waitcnt vmcnt(6)
  s_add_u32 m0, s77, 124928
  s_mov_b32 s3, 4608
  buffer_load_dwordx4 v80, s[40:43], s3 offen sc1 lds
  s_waitcnt vmcnt(6)
  s_add_u32 m0, s77, 125952
  s_mov_b32 s3, 13824
  buffer_load_dwordx4 v80, s[40:43], s3 offen sc1 lds
  s_waitcnt vmcnt(6)
  s_add_u32 m0, s77, 126976
  s_mov_b32 s3, 23040
  buffer_load_dwordx4 v80, s[40:43], s3 offen sc1 lds
  s_mov_b32 s3, 0x80008000
  s_cmp_ge_u32 s14, 16
  s_cselect_b32 s17, s3, 0
  s_cmp_ge_u32 s12, 4
  s_cselect_b32 s18, s3, 0
  s_xor_b32 s19, s17, s18
  s_xor_b32 s17, s17, s3
  v_xor_b32 v114, s19, v96
  v_xor_b32 v98, s17, v112
  v_xor_b32 v112, s18, v112
  v_xor_b32 v115, s19, v97
  v_xor_b32 v99, s17, v113
  v_xor_b32 v113, s18, v113
  v_xor_b32 v118, s19, v100
  v_xor_b32 v102, s17, v116
  v_xor_b32 v116, s18, v116
  v_xor_b32 v119, s19, v101
  v_xor_b32 v103, s17, v117
  v_xor_b32 v117, s18, v117
  v_xor_b32 v122, s19, v104
  v_xor_b32 v106, s17, v120
  v_xor_b32 v120, s18, v120
  v_xor_b32 v123, s19, v105
  v_xor_b32 v107, s17, v121
  v_xor_b32 v121, s18, v121
  v_xor_b32 v126, s19, v108
  v_xor_b32 v110, s17, v124
  v_xor_b32 v124, s18, v124
  v_xor_b32 v127, s19, v109
  v_xor_b32 v111, s17, v125
  v_xor_b32 v125, s18, v125
  s_cmp_eq_u32 s13, 0
  s_cbranch_scc0 L_twd
  s_cmp_eq_u32 s14, 0
  s_cselect_b32 s17, -1, 0
  s_cselect_b32 s19, 0, -1
  v_and_b32 v98, s19, v96
  v_and_b32 v96, s17, v96
  v_and_b32 v99, s19, v97
  v_and_b32 v97, s17, v97
  v_and_b32 v102, s19, v100
  v_and_b32 v100, s17, v100
  v_and_b32 v103, s19, v101
  v_and_b32 v101, s17, v101
  v_and_b32 v106, s19, v104
  v_and_b32 v104, s17, v104
  v_and_b32 v107, s19, v105
  v_and_b32 v105, s17, v105
  v_and_b32 v110, s19, v108
  v_and_b32 v108, s17, v108
  v_and_b32 v111, s19, v109
  v_and_b32 v109, s17, v109
  v_and_b32 v114, s19, v112
  v_and_b32 v112, s17, v112
  v_and_b32 v115, s19, v113
  v_and_b32 v113, s17, v113
  v_and_b32 v118, s19, v116
  v_and_b32 v116, s17, v116
  v_and_b32 v119, s19, v117
  v_and_b32 v117, s17, v117
  v_and_b32 v122, s19, v120
  v_and_b32 v120, s17, v120
  v_and_b32 v123, s19, v121
  v_and_b32 v121, s17, v121
  v_and_b32 v126, s19, v124
  v_and_b32 v124, s17, v124
  v_and_b32 v127, s19, v125
  v_and_b32 v125, s17, v125
L_twd:
  s_lshl_b32 s3, s15, 1
  s_add_u32 s3, s3, s16
  s_mul_i32 s79, s3, 18432
  s_add_u32 s79, s79, 5505024
  s_lshl_b32 s80, s3, 6
  s_add_u32 s80, s80, 7864320
  v_lshlrev_b32 v248, 2, v1
  v_lshlrev_b32_e64 v253, 3, v1
  v_lshl_add_u32 v253, v2, 8, v253
L_pad10:
  s_mul_i32 s3, s4, 2560
  s_add_u32 s3, s3, 90112
  v_mul_u32_u24 v4, 160, v1
  v_lshl_add_u32 v4, v2, 3, v4
  v_add_u32_e64 v249, s3, v4
  v_lshl_add_u32 v4, v13, 4, v3
  v_add_u32_e64 v250, s3, v4
  v_mul_u32_u24 v4, 73584, v13
  v_add_u32_e64 v251, v4, v3
  s_lshl_b32 s3, s16, 10
  s_add_u32 s3, s3, s15
  s_mul_i32 s83, s3, 1152
  s_mul_i32 s3, s12, 144
  s_add_u32 s83, s83, s3
  s_mov_b32 s32, s52
  s_mov_b32 s33, s53
  s_mov_b32 s34, 2359296
  s_mov_b32 s35, 0x20000
  v_lshlrev_b32 v4, 4, v1
  v_lshl_add_u32 v8, v2, 10, v4
  v_lshl_add_u32 v9, v2, 7, v4
  v_lshrrev_b32_e64 v4, 3, v1
  v_lshl_add_u32 v9, v4, 18, v9
  s_lshl_b32 s82, s14, 1
  s_lshr_b32 s3, s12, 2
  s_add_u32 s82, s82, s3
  s_mul_i32 s82, s82, 1152
  s_add_u32 s82, s82, 7929864
  v_add_u32 v10, 0, v3
  v_add_u32 v11, 55296, v3
  v_add_u32 v12, 4096, v9
  v_add_u32 v14, 59392, v9
  v_add_u32 v8, 120832, v8
  v_add_u32 v9, 120832, v9
  s_add_u32 s56, s79, 4096
  s_add_u32 s57, s79, 8192
  s_add_u32 s58, s79, 12288
  s_add_u32 s59, s79, 16384
  s_waitcnt vmcnt(5)
  s_add_u32 m0, s77, 128000
  s_mov_b32 s3, 32256
  buffer_load_dwordx4 v80, s[40:43], s3 offen sc1 lds
  s_waitcnt vmcnt(5)
  s_add_u32 m0, s77, 129024
  s_mov_b32 s3, 0
  buffer_load_dwordx4 v81, s[40:43], s3 offen sc1 lds
  s_waitcnt vmcnt(5)
  s_add_u32 m0, s84, 73728
  s_add_u32 s3, s84, 73728
  buffer_load_dwordx4 v3, s[24:27], s3 offen sc1 lds
  s_waitcnt vmcnt(5)
  s_add_u32 m0, s84, 77824
  s_add_u32 s3, s84, 77824
  buffer_load_dwordx4 v3, s[24:27], s3 offen sc1 lds
  s_waitcnt vmcnt(5)
  s_add_u32 m0, s84, 81920
  s_add_u32 s3, s84, 81920
  buffer_load_dwordx4 v3, s[24:27], s3 offen sc1 lds
  ds_read_b128 v[128:131], v10 offset:0
  ds_read_b128 v[132:135], v10 offset:1024
  ds_read_b128 v[136:139], v10 offset:2048
  ds_read_b128 v[140:143], v10 offset:3072
  ds_read_b128 v[144:147], v12 offset:0
  ds_read_b128 v[148:151], v10 offset:4608
  ds_read_b128 v[152:155], v10 offset:5632
  ds_read_b128 v[156:159], v10 offset:6656
  ds_read_b128 v[160:163], v10 offset:7680
  ds_read_b128 v[164:167], v12 offset:4608
  ds_read_b128 v[168:171], v10 offset:9216
  ds_read_b128 v[172:175], v10 offset:10240
  ds_read_b128 v[176:179], v10 offset:11264
  ds_read_b128 v[180:183], v10 offset:12288
  ds_read_b128 v[184:187], v12 offset:9216
  ds_read_b128 v[188:191], v10 offset:13824
  ds_read_b128 v[192:195], v10 offset:14848
  ds_read_b128 v[196:199], v10 offset:15872
  ds_read_b128 v[200:203], v10 offset:16896
  ds_read_b128 v[204:207], v12 offset:13824
  s_cmp_lg_u32 s4, 0
  s_cbranch_scc1 L_c216
  s_mov_b32 s87, 0
L_sl17:
  s_load_dword s31, s[40:41], s82 glc
  s_add_u32 s87, s87, 1
  s_cmp_gt_u32 s87, 200000
  s_cbranch_scc1 L_se18
L_sc19:
  s_waitcnt lgkmcnt(0)
  s_cmp_lt_u32 s31, 32
  s_cbranch_scc1 L_sl17
L_se18:
  s_waitcnt lgkmcnt(0)
L_c216:
  s_waitcnt vmcnt(0)
  s_barrier
  buffer_load_dwordx4 v[56:59], v3, s[40:43], s79 offen offset:0 sc1
  ds_read_b128 v[208:211], v8 offset:0
  ds_read_b128 v[212:215], v8 offset:256
  ds_read_b128 v[216:219], v8 offset:512
  ds_read_b128 v[220:223], v8 offset:768
  ds_read_b128 v[224:227], v9 offset:8192
  buffer_load_dwordx4 v[60:63], v3, s[40:43], s79 offen offset:1024 sc1
  ds_read_b128 v[228:231], v8 offset:9216
  ds_read_b128 v[232:235], v8 offset:9472
  ds_read_b128 v[236:239], v8 offset:9728
  ds_read_b128 v[240:243], v8 offset:9984
  ds_read_b128 v[244:247], v9 offset:17408
  buffer_load_dwordx4 v[64:67], v3, s[40:43], s79 offen offset:2048 sc1
  s_waitcnt lgkmcnt(5)
  v_mfma_f32_16x16x32_bf16 v[16:19], v[208:211], v[96:99], 0
  ds_read_b128 v[208:211], v8 offset:18432
  v_mfma_f32_16x16x32_bf16 v[20:23], v[212:215], v[96:99], 0
  ds_read_b128 v[212:215], v8 offset:18688
  buffer_load_dwordx4 v[68:71], v3, s[40:43], s79 offen offset:3072 sc1
  v_mfma_f32_16x16x32_bf16 v[24:27], v[216:219], v[96:99], 0
  ds_read_b128 v[216:219], v8 offset:18944
  v_mfma_f32_16x16x32_bf16 v[28:31], v[220:223], v[96:99], 0
  ds_read_b128 v[220:223], v8 offset:19200
  buffer_load_dwordx4 v[72:75], v3, s[40:43], s56 offen offset:0 sc1
  v_mfma_f32_16x16x32_bf16 v[32:35], v[224:227], v[96:99], 0
  ds_read_b128 v[224:227], v9 offset:26624
  s_waitcnt lgkmcnt(5)
  v_mfma_f32_16x16x32_bf16 v[16:19], v[228:231], v[100:103], v[16:19]
  ds_read_b128 v[228:231], v8 offset:27648
  v_mfma_f32_16x16x32_bf16 v[20:23], v[232:235], v[100:103], v[20:23]
  ds_read_b128 v[232:235], v8 offset:27904
  buffer_load_dwordx4 v[76:79], v3, s[40:43], s56 offen offset:1024 sc1
  v_mfma_f32_16x16x32_bf16 v[24:27], v[236:239], v[100:103], v[24:27]
  ds_read_b128 v[236:239], v8 offset:28160
  v_mfma_f32_16x16x32_bf16 v[28:31], v[240:243], v[100:103], v[28:31]
  ds_read_b128 v[240:243], v8 offset:28416
  buffer_load_dwordx4 v[80:83], v3, s[40:43], s56 offen offset:2048 sc1
  v_mfma_f32_16x16x32_bf16 v[32:35], v[244:247], v[100:103], v[32:35]
  ds_read_b128 v[244:247], v9 offset:35840
  s_waitcnt lgkmcnt(5)
  v_mfma_f32_16x16x32_bf16 v[16:19], v[208:211], v[104:107], v[16:19]
  ds_read_b128 v[208:211], v8 offset:4096
  v_mfma_f32_16x16x32_bf16 v[20:23], v[212:215], v[104:107], v[20:23]
  ds_read_b128 v[212:215], v8 offset:4352
  buffer_load_dwordx4 v[84:87], v3, s[40:43], s56 offen offset:3072 sc1
  v_mfma_f32_16x16x32_bf16 v[24:27], v[216:219], v[104:107], v[24:27]
  ds_read_b128 v[216:219], v8 offset:4608
  v_mfma_f32_16x16x32_bf16 v[28:31], v[220:223], v[104:107], v[28:31]
  ds_read_b128 v[220:223], v8 offset:4864
  v_mfma_f32_16x16x32_bf16 v[32:35], v[224:227], v[104:107], v[32:35]
  ds_read_b128 v[224:227], v9 offset:8704
  s_waitcnt lgkmcnt(5)
  v_mfma_f32_16x16x32_bf16 v[16:19], v[228:231], v[108:111], v[16:19]
L_pad11:
  ds_read_b128 v[228:231], v8 offset:13312
  v_mfma_f32_16x16x32_bf16 v[20:23], v[232:235], v[108:111], v[20:23]
  ds_read_b128 v[232:235], v8 offset:13568
  v_mfma_f32_16x16x32_bf16 v[24:27], v[236:239], v[108:111], v[24:27]
  ds_read_b128 v[236:239], v8 offset:13824
  v_mfma_f32_16x16x32_bf16 v[28:31], v[240:243], v[108:111], v[28:31]
  ds_read_b128 v[240:243], v8 offset:14080
  v_mfma_f32_16x16x32_bf16 v[32:35], v[244:247], v[108:111], v[32:35]
  ds_read_b128 v[244:247], v9 offset:17920
  s_waitcnt lgkmcnt(5)
  v_mfma_f32_16x16x32_bf16 v[16:19], v[208:211], v[112:115], v[16:19]
  ds_read_b128 v[208:211], v8 offset:22528
  v_mfma_f32_16x16x32_bf16 v[20:23], v[212:215], v[112:115], v[20:23]
  ds_read_b128 v[212:215], v8 offset:22784
  v_mfma_f32_16x16x32_bf16 v[24:27], v[216:219], v[112:115], v[24:27]
  ds_read_b128 v[216:219], v8 offset:23040
  v_mfma_f32_16x16x32_bf16 v[28:31], v[220:223], v[112:115], v[28:31]
  ds_read_b128 v[220:223], v8 offset:23296
  v_mfma_f32_16x16x32_bf16 v[32:35], v[224:227], v[112:115], v[32:35]
  ds_read_b128 v[224:227], v9 offset:27136
  s_waitcnt lgkmcnt(5)
  v_mfma_f32_16x16x32_bf16 v[16:19], v[228:231], v[116:119], v[16:19]
  ds_read_b128 v[228:231], v8 offset:31744
  v_mfma_f32_16x16x32_bf16 v[20:23], v[232:235], v[116:119], v[20:23]
  ds_read_b128 v[232:235], v8 offset:32000
  v_mfma_f32_16x16x32_bf16 v[24:27], v[236:239], v[116:119], v[24:27]
  ds_read_b128 v[236:239], v8 offset:32256
  v_mfma_f32_16x16x32_bf16 v[28:31], v[240:243], v[116:119], v[28:31]
  ds_read_b128 v[240:243], v8 offset:32512
  v_mfma_f32_16x16x32_bf16 v[32:35], v[244:247], v[116:119], v[32:35]
  ds_read_b128 v[244:247], v9 offset:36352
  s_waitcnt lgkmcnt(5)
  v_mfma_f32_16x16x32_bf16 v[16:19], v[208:211], v[120:123], v[16:19]
  v_mfma_f32_16x16x32_bf16 v[20:23], v[212:215], v[120:123], v[20:23]
  buffer_load_dwordx4 v[88:91], v3, s[40:43], s57 offen offset:0 sc1
  v_mfma_f32_16x16x32_bf16 v[24:27], v[216:219], v[120:123], v[24:27]
  v_mfma_f32_16x16x32_bf16 v[28:31], v[220:223], v[120:123], v[28:31]
  buffer_load_dwordx4 v[92:95], v3, s[40:43], s57 offen offset:1024 sc1
  v_mfma_f32_16x16x32_bf16 v[32:35], v[224:227], v[120:123], v[32:35]
  s_waitcnt lgkmcnt(0)
  v_mfma_f32_16x16x32_bf16 v[16:19], v[228:231], v[124:127], v[16:19]
  v_mfma_f32_16x16x32_bf16 v[20:23], v[232:235], v[124:127], v[20:23]
  v_mfma_f32_16x16x32_bf16 v[24:27], v[236:239], v[124:127], v[24:27]
  v_mfma_f32_16x16x32_bf16 v[28:31], v[240:243], v[124:127], v[28:31]
  v_mfma_f32_16x16x32_bf16 v[32:35], v[244:247], v[124:127], v[32:35]
  s_mov_b32 s87, 0
L_fin:
  s_waitcnt vmcnt(9)
  v_mfma_f32_16x16x32_bf16 v[36:39], v[128:131], v[56:59], 0
  buffer_load_dwordx4 v[96:99], v3, s[40:43], s57 offen offset:2048 sc1
  ds_read_b128 v[128:131], v10 offset:18432
  v_mfma_f32_16x16x32_bf16 v[40:43], v[132:135], v[56:59], 0
  ds_read_b128 v[132:135], v10 offset:19456
  v_mfma_f32_16x16x32_bf16 v[44:47], v[136:139], v[56:59], 0
  ds_read_b128 v[136:139], v10 offset:20480
  v_mfma_f32_16x16x32_bf16 v[48:51], v[140:143], v[56:59], 0
  ds_read_b128 v[140:143], v10 offset:21504
  v_mfma_f32_16x16x32_bf16 v[52:55], v[144:147], v[56:59], 0
  ds_read_b128 v[144:147], v12 offset:18432
  s_waitcnt vmcnt(9)
  v_mfma_f32_16x16x32_bf16 v[36:39], v[148:151], v[60:63], v[36:39]
  buffer_load_dwordx4 v[100:103], v3, s[40:43], s57 offen offset:3072 sc1
  ds_read_b128 v[148:151], v10 offset:23040
  v_mfma_f32_16x16x32_bf16 v[40:43], v[152:155], v[60:63], v[40:43]
  ds_read_b128 v[152:155], v10 offset:24064
  v_mfma_f32_16x16x32_bf16 v[44:47], v[156:159], v[60:63], v[44:47]
  ds_read_b128 v[156:159], v10 offset:25088
  v_mfma_f32_16x16x32_bf16 v[48:51], v[160:163], v[60:63], v[48:51]
  ds_read_b128 v[160:163], v10 offset:26112
  v_mfma_f32_16x16x32_bf16 v[52:55], v[164:167], v[60:63], v[52:55]
  ds_read_b128 v[164:167], v12 offset:23040
  s_waitcnt vmcnt(9)
  v_mfma_f32_16x16x32_bf16 v[36:39], v[168:171], v[64:67], v[36:39]
  buffer_load_dwordx4 v[104:107], v3, s[40:43], s58 offen offset:0 sc1
  ds_read_b128 v[168:171], v10 offset:27648
  v_mfma_f32_16x16x32_bf16 v[40:43], v[172:175], v[64:67], v[40:43]
  ds_read_b128 v[172:175], v10 offset:28672
  v_mfma_f32_16x16x32_bf16 v[44:47], v[176:179], v[64:67], v[44:47]
  ds_read_b128 v[176:179], v10 offset:29696
  v_mfma_f32_16x16x32_bf16 v[48:51], v[180:183], v[64:67], v[48:51]
  ds_read_b128 v[180:183], v10 offset:30720
  v_mfma_f32_16x16x32_bf16 v[52:55], v[184:187], v[64:67], v[52:55]
  ds_read_b128 v[184:187], v12 offset:27648
  s_waitcnt vmcnt(9)
  v_mfma_f32_16x16x32_bf16 v[36:39], v[188:191], v[68:71], v[36:39]
  buffer_load_dwordx4 v[108:111], v3, s[40:43], s58 offen offset:1024 sc1
  ds_read_b128 v[188:191], v10 offset:32256
  v_mfma_f32_16x16x32_bf16 v[40:43], v[192:195], v[68:71], v[40:43]
  ds_read_b128 v[192:195], v10 offset:33280
  v_mfma_f32_16x16x32_bf16 v[44:47], v[196:199], v[68:71], v[44:47]
  ds_read_b128 v[196:199], v10 offset:34304
  v_mfma_f32_16x16x32_bf16 v[48:51], v[200:203], v[68:71], v[48:51]
  ds_read_b128 v[200:203], v10 offset:35328
  v_mfma_f32_16x16x32_bf16 v[52:55], v[204:207], v[68:71], v[52:55]
  ds_read_b128 v[204:207], v12 offset:32256
  s_waitcnt vmcnt(9) lgkmcnt(15)
  v_mfma_f32_16x16x32_bf16 v[36:39], v[128:131], v[72:75], v[36:39]
  buffer_load_dwordx4 v[112:115], v3, s[40:43], s58 offen offset:2048 sc1
  ds_read_b128 v[128:131], v10 offset:36864
  v_mfma_f32_16x16x32_bf16 v[40:43], v[132:135], v[72:75], v[40:43]
  ds_read_b128 v[132:135], v10 offset:37888
  v_mfma_f32_16x16x32_bf16 v[44:47], v[136:139], v[72:75], v[44:47]
  ds_read_b128 v[136:139], v10 offset:38912
  v_mfma_f32_16x16x32_bf16 v[48:51], v[140:143], v[72:75], v[48:51]
  ds_read_b128 v[140:143], v10 offset:39936
  v_mfma_f32_16x16x32_bf16 v[52:55], v[144:147], v[72:75], v[52:55]
  ds_read_b128 v[144:147], v12 offset:36864
  s_waitcnt vmcnt(9) lgkmcnt(15)
  v_mfma_f32_16x16x32_bf16 v[36:39], v[148:151], v[76:79], v[36:39]
  buffer_load_dwordx4 v[116:119], v3, s[40:43], s58 offen offset:3072 sc1
  ds_read_b128 v[148:151], v10 offset:41472
  v_mfma_f32_16x16x32_bf16 v[40:43], v[152:155], v[76:79], v[40:43]
  ds_read_b128 v[152:155], v10 offset:42496
  v_mfma_f32_16x16x32_bf16 v[44:47], v[156:159], v[76:79], v[44:47]
  ds_read_b128 v[156:159], v10 offset:43520
  v_mfma_f32_16x16x32_bf16 v[48:51], v[160:163], v[76:79], v[48:51]
  ds_read_b128 v[160:163], v10 offset:44544
  v_mfma_f32_16x16x32_bf16 v[52:55], v[164:167], v[76:79], v[52:55]
  ds_read_b128 v[164:167], v12 offset:41472
  s_waitcnt vmcnt(9) lgkmcnt(15)
  v_mfma_f32_16x16x32_bf16 v[36:39], v[168:171], v[80:83], v[36:39]
  buffer_load_dwordx2 v[120:121], v253, s[40:43], s59 offen offset:0 sc1
  buffer_load_dwordx2 v[122:123], v253, s[40:43], s59 offen offset:128 sc1
  ds_read_b128 v[168:171], v10 offset:46080
  v_mfma_f32_16x16x32_bf16 v[40:43], v[172:175], v[80:83], v[40:43]
  ds_read_b128 v[172:175], v10 offset:47104
  v_mfma_f32_16x16x32_bf16 v[44:47], v[176:179], v[80:83], v[44:47]
  ds_read_b128 v[176:179], v10 offset:48128
  v_mfma_f32_16x16x32_bf16 v[48:51], v[180:183], v[80:83], v[48:51]
  ds_read_b128 v[180:183], v10 offset:49152
  v_mfma_f32_16x16x32_bf16 v[52:55], v[184:187], v[80:83], v[52:55]
  ds_read_b128 v[184:187], v12 offset:46080
  s_waitcnt vmcnt(10) lgkmcnt(15)
  v_mfma_f32_16x16x32_bf16 v[36:39], v[188:191], v[84:87], v[36:39]
  buffer_load_dwordx2 v[124:125], v253, s[40:43], s59 offen offset:1024 sc1
L_pad12:
  s_cbranch_execz L_retwo1
  buffer_load_dwordx2 v[126:127], v253, s[40:43], s59 offen offset:1152 sc1
  ds_read_b128 v[188:191], v10 offset:50688
  v_mfma_f32_16x16x32_bf16 v[40:43], v[192:195], v[84:87], v[40:43]
  ds_read_b128 v[192:195], v10 offset:51712
  v_mfma_f32_16x16x32_bf16 v[44:47], v[196:199], v[84:87], v[44:47]
  ds_read_b128 v[196:199], v10 offset:52736
  v_mfma_f32_16x16x32_bf16 v[48:51], v[200:203], v[84:87], v[48:51]
  ds_read_b128 v[200:203], v10 offset:53760
  v_mfma_f32_16x16x32_bf16 v[52:55], v[204:207], v[84:87], v[52:55]
  ds_read_b128 v[204:207], v12 offset:50688
  s_waitcnt vmcnt(11) lgkmcnt(15)
  v_mfma_f32_16x16x32_bf16 v[36:39], v[128:131], v[88:91], v[36:39]
  buffer_load_dword v4, v248, s[40:43], s80 offen sc1
  ds_read_b128 v[128:131], v11 offset:0
  v_mfma_f32_16x16x32_bf16 v[40:43], v[132:135], v[88:91], v[40:43]
  ds_read_b128 v[132:135], v11 offset:1024
  v_mfma_f32_16x16x32_bf16 v[44:47], v[136:139], v[88:91], v[44:47]
  ds_read_b128 v[136:139], v11 offset:2048
  v_mfma_f32_16x16x32_bf16 v[48:51], v[140:143], v[88:91], v[48:51]
  ds_read_b128 v[140:143], v11 offset:3072
  v_mfma_f32_16x16x32_bf16 v[52:55], v[144:147], v[88:91], v[52:55]
  ds_read_b128 v[144:147], v14 offset:0
  s_waitcnt vmcnt(11) lgkmcnt(15)
  v_mfma_f32_16x16x32_bf16 v[36:39], v[148:151], v[92:95], v[36:39]
  ds_read_b128 v[148:151], v11 offset:4608
  v_mfma_f32_16x16x32_bf16 v[40:43], v[152:155], v[92:95], v[40:43]
  ds_read_b128 v[152:155], v11 offset:5632
  v_mfma_f32_16x16x32_bf16 v[44:47], v[156:159], v[92:95], v[44:47]
  ds_read_b128 v[156:159], v11 offset:6656
  v_mfma_f32_16x16x32_bf16 v[48:51], v[160:163], v[92:95], v[48:51]
  ds_read_b128 v[160:163], v11 offset:7680
  v_mfma_f32_16x16x32_bf16 v[52:55], v[164:167], v[92:95], v[52:55]
  ds_read_b128 v[164:167], v14 offset:4608
  s_waitcnt vmcnt(10) lgkmcnt(15)
  v_mfma_f32_16x16x32_bf16 v[36:39], v[168:171], v[96:99], v[36:39]
  ds_read_b128 v[168:171], v11 offset:9216
  v_mfma_f32_16x16x32_bf16 v[40:43], v[172:175], v[96:99], v[40:43]
  ds_read_b128 v[172:175], v11 offset:10240
  v_mfma_f32_16x16x32_bf16 v[44:47], v[176:179], v[96:99], v[44:47]
  ds_read_b128 v[176:179], v11 offset:11264
  v_mfma_f32_16x16x32_bf16 v[48:51], v[180:183], v[96:99], v[48:51]
  ds_read_b128 v[180:183], v11 offset:12288
  v_mfma_f32_16x16x32_bf16 v[52:55], v[184:187], v[96:99], v[52:55]
  ds_read_b128 v[184:187], v14 offset:9216
  s_waitcnt vmcnt(9) lgkmcnt(15)
  v_mfma_f32_16x16x32_bf16 v[36:39], v[188:191], v[100:103], v[36:39]
  ds_read_b128 v[188:191], v11 offset:13824
  v_mfma_f32_16x16x32_bf16 v[40:43], v[192:195], v[100:103], v[40:43]
  ds_read_b128 v[192:195], v11 offset:14848
  v_mfma_f32_16x16x32_bf16 v[44:47], v[196:199], v[100:103], v[44:47]
  ds_read_b128 v[196:199], v11 offset:15872
  v_mfma_f32_16x16x32_bf16 v[48:51], v[200:203], v[100:103], v[48:51]
  ds_read_b128 v[200:203], v11 offset:16896
  v_mfma_f32_16x16x32_bf16 v[52:55], v[204:207], v[100:103], v[52:55]
  ds_read_b128 v[204:207], v14 offset:13824
  s_waitcnt vmcnt(8) lgkmcnt(15)
  v_mfma_f32_16x16x32_bf16 v[36:39], v[128:131], v[104:107], v[36:39]
  ds_read_b128 v[128:131], v11 offset:18432
  v_mfma_f32_16x16x32_bf16 v[40:43], v[132:135], v[104:107], v[40:43]
  ds_read_b128 v[132:135], v11 offset:19456
  v_mfma_f32_16x16x32_bf16 v[44:47], v[136:139], v[104:107], v[44:47]
  ds_read_b128 v[136:139], v11 offset:20480
  v_mfma_f32_16x16x32_bf16 v[48:51], v[140:143], v[104:107], v[48:51]
  ds_read_b128 v[140:143], v11 offset:21504
  v_mfma_f32_16x16x32_bf16 v[52:55], v[144:147], v[104:107], v[52:55]
  ds_read_b128 v[144:147], v14 offset:18432
  s_waitcnt vmcnt(7) lgkmcnt(15)
  v_mfma_f32_16x16x32_bf16 v[36:39], v[148:151], v[108:111], v[36:39]
  ds_read_b128 v[148:151], v11 offset:23040
  v_mfma_f32_16x16x32_bf16 v[40:43], v[152:155], v[108:111], v[40:43]
  ds_read_b128 v[152:155], v11 offset:24064
  v_mfma_f32_16x16x32_bf16 v[44:47], v[156:159], v[108:111], v[44:47]
  ds_read_b128 v[156:159], v11 offset:25088
  v_mfma_f32_16x16x32_bf16 v[48:51], v[160:163], v[108:111], v[48:51]
  ds_read_b128 v[160:163], v11 offset:26112
  v_mfma_f32_16x16x32_bf16 v[52:55], v[164:167], v[108:111], v[52:55]
  ds_read_b128 v[164:167], v14 offset:23040
  s_waitcnt vmcnt(6) lgkmcnt(15)
  v_mfma_f32_16x16x32_bf16 v[36:39], v[168:171], v[112:115], v[36:39]
  s_waitcnt vmcnt(5) lgkmcnt(10)
  v_mfma_f32_16x16x32_bf16 v[36:39], v[188:191], v[116:119], v[36:39]
  s_waitcnt vmcnt(3) lgkmcnt(5)
  v_mfma_f32_16x16x32_bf16 v[36:39], v[128:131], v[120:123], v[36:39]
  s_waitcnt vmcnt(1) lgkmcnt(0)
  v_mfma_f32_16x16x32_bf16 v[36:39], v[148:151], v[124:127], v[36:39]
  v_mfma_f32_16x16x32_bf16 v[40:43], v[172:175], v[112:115], v[40:43]
  v_mfma_f32_16x16x32_bf16 v[40:43], v[192:195], v[116:119], v[40:43]
  v_mfma_f32_16x16x32_bf16 v[40:43], v[132:135], v[120:123], v[40:43]
  v_mfma_f32_16x16x32_bf16 v[40:43], v[152:155], v[124:127], v[40:43]
  s_waitcnt vmcnt(0)
  v_mfma_f32_16x16x32_bf16 v[44:47], v[176:179], v[112:115], v[44:47]
  s_nop 1
  v_cmp_u_f32 vcc, v36, v36
  v_fmac_f32_e64 v36, v4, v16
  v_mfma_f32_16x16x32_bf16 v[44:47], v[196:199], v[116:119], v[44:47]
  v_fmac_f32 v37, v4, v17
  v_fmac_f32 v38, v4, v18
  v_mfma_f32_16x16x32_bf16 v[44:47], v[136:139], v[120:123], v[44:47]
  v_fmac_f32_e64 v39, v4, v19
  v_cvt_pk_bf16_f32 v36, v36, v37
  v_mfma_f32_16x16x32_bf16 v[44:47], v[156:159], v[124:127], v[44:47]
  v_cvt_pk_bf16_f32 v37, v38, v39
  ds_write_b64 v249, v[36:37] offset:0
  v_mfma_f32_16x16x32_bf16 v[48:51], v[180:183], v[112:115], v[48:51]
  v_fmac_f32 v40, v4, v20
  v_fmac_f32 v41, v4, v21
  v_mfma_f32_16x16x32_bf16 v[48:51], v[200:203], v[116:119], v[48:51]
  v_fmac_f32 v42, v4, v22
  v_fmac_f32 v43, v4, v23
  v_mfma_f32_16x16x32_bf16 v[48:51], v[140:143], v[120:123], v[48:51]
  v_cvt_pk_bf16_f32 v40, v40, v41
  v_cvt_pk_bf16_f32 v41, v42, v43
  v_mfma_f32_16x16x32_bf16 v[48:51], v[160:163], v[124:127], v[48:51]
  ds_write_b64 v249, v[40:41] offset:32
  v_mfma_f32_16x16x32_bf16 v[52:55], v[184:187], v[112:115], v[52:55]
  v_fmac_f32 v44, v4, v24
  v_fmac_f32 v45, v4, v25
  v_mfma_f32_16x16x32_bf16 v[52:55], v[204:207], v[116:119], v[52:55]
  v_fmac_f32 v46, v4, v26
  v_fmac_f32 v47, v4, v27
  v_mfma_f32_16x16x32_bf16 v[52:55], v[144:147], v[120:123], v[52:55]
  v_cvt_pk_bf16_f32 v44, v44, v45
  v_cvt_pk_bf16_f32 v45, v46, v47
  v_mfma_f32_16x16x32_bf16 v[52:55], v[164:167], v[124:127], v[52:55]
  ds_write_b64 v249, v[44:45] offset:64
  v_fmac_f32 v48, v4, v28
  v_fmac_f32 v49, v4, v29
  v_fmac_f32 v50, v4, v30
  v_fmac_f32 v51, v4, v31
  v_cvt_pk_bf16_f32 v48, v48, v49
  v_cvt_pk_bf16_f32 v49, v50, v51
  ds_write_b64 v249, v[48:49] offset:96
  v_pk_fma_f32 v[52:53], v[32:33], v[4:5], v[52:53] op_sel_hi:[1,0,1]
  v_pk_fma_f32 v[54:55], v[34:35], v[4:5], v[54:55] op_sel_hi:[1,0,1]
  v_cvt_pk_bf16_f32 v52, v52, v53
  v_cvt_pk_bf16_f32 v53, v54, v55
  ds_write_b64 v249, v[52:53] offset:128
  ds_read_b128 v[208:211], v250 offset:0
  ds_read_b128 v[212:215], v250 offset:1120
  ds_read_b128 v[216:219], v250 offset:2240
  s_cbranch_vccz L_fok
  s_add_u32 s87, s87, 1
L_pad13:
  s_cmp_gt_u32 s87, 2000
  s_cbranch_scc1 L_fok
  buffer_load_dwordx4 v[56:59], v3, s[40:43], s79 offen offset:0 sc1
  buffer_load_dwordx4 v[60:63], v3, s[40:43], s79 offen offset:1024 sc1
  buffer_load_dwordx4 v[64:67], v3, s[40:43], s79 offen offset:2048 sc1
  buffer_load_dwordx4 v[68:71], v3, s[40:43], s79 offen offset:3072 sc1
  buffer_load_dwordx4 v[72:75], v3, s[40:43], s56 offen offset:0 sc1
  buffer_load_dwordx4 v[76:79], v3, s[40:43], s56 offen offset:1024 sc1
  buffer_load_dwordx4 v[80:83], v3, s[40:43], s56 offen offset:2048 sc1
  buffer_load_dwordx4 v[84:87], v3, s[40:43], s56 offen offset:3072 sc1
  buffer_load_dwordx4 v[88:91], v3, s[40:43], s57 offen offset:0 sc1
  buffer_load_dwordx4 v[92:95], v3, s[40:43], s57 offen offset:1024 sc1
  ds_read_b128 v[128:131], v10 offset:0
  ds_read_b128 v[132:135], v10 offset:1024
  ds_read_b128 v[136:139], v10 offset:2048
  ds_read_b128 v[140:143], v10 offset:3072
  ds_read_b128 v[144:147], v12 offset:0
  ds_read_b128 v[148:151], v10 offset:4608
  ds_read_b128 v[152:155], v10 offset:5632
  ds_read_b128 v[156:159], v10 offset:6656
  ds_read_b128 v[160:163], v10 offset:7680
  ds_read_b128 v[164:167], v12 offset:4608
  ds_read_b128 v[168:171], v10 offset:9216
  ds_read_b128 v[172:175], v10 offset:10240
  ds_read_b128 v[176:179], v10 offset:11264
  ds_read_b128 v[180:183], v10 offset:12288
  ds_read_b128 v[184:187], v12 offset:9216
  ds_read_b128 v[188:191], v10 offset:13824
  ds_read_b128 v[192:195], v10 offset:14848
  ds_read_b128 v[196:199], v10 offset:15872
  ds_read_b128 v[200:203], v10 offset:16896
  ds_read_b128 v[204:207], v12 offset:13824
  s_waitcnt vmcnt(0) lgkmcnt(0)
  s_branch L_fin
L_fok:
  s_waitcnt lgkmcnt(2)
  buffer_store_dwordx4 v[208:211], v251, s[32:35], s83 offen
  s_add_u32 s83, s83, 516096
  s_waitcnt lgkmcnt(1)
  buffer_store_dwordx4 v[212:215], v251, s[32:35], s83 offen
  s_add_u32 s83, s83, 516096
  s_mov_b64 exec, 0x3ffff
  s_waitcnt lgkmcnt(0)
  buffer_store_dwordx4 v[216:219], v251, s[32:35], s83 offen
L_end:
  s_endpgm
L_B2:
  s_setprio 1
  s_load_dwordx8 s[48:55], s[0:1], 64
  s_load_dwordx2 s[40:41], s[0:1], 96
  s_add_u32 s57, s56, 1
  s_sub_u32 s3, s57, 9
  s_min_u32 s57, s57, s3
  s_and_b32 s3, s6, 7
  s_mul_i32 s44, s3, 36
  s_and_b32 s45, s4, 1
  s_lshl_b32 s45, s45, 4
  s_add_u32 s3, s45, s44
  v_add_u32 v28, s3, v1
  s_cmp_ge_u32 s6, 8
  s_cselect_b32 s46, 0x3e800000, 0
  v_mov_b32_e64 v29, s46
  s_add_u32 s45, s45, s6
  s_cmp_eq_u32 s45, 8
  s_cselect_b32 vcc_lo, 0x00010001, 0
  s_mov_b32 vcc_hi, vcc_lo
  v_mov_b32 v4, 288
  v_cndmask_b32 v28, v28, v4, vcc
  v_cndmask_b32 v29, v29, v20, vcc
  v_cvt_f32_u32 v28, v28
  v_mul_f32 v28, 0x3ae38e39, v28
  s_lshr_b32 s3, s4, 1
  s_lshl_b32 s3, s3, 5
  v_lshl_add_u32 v30, v2, 3, s3
  s_add_u32 s44, s44, 32
  s_lshl_b32 s3, s4, 10
  v_add_u32 v10, 120832, v3
  v_add_u32_e64 v14, s3, v10
  v_lshl_add_u32 v48, s56, 6, v30
  v_cvt_f32_u32 v48, v48
  v_add_f32 v66, v28, v28
  v_fma_f32 v48, v28, v48, v29
  v_mul_f32 v64, 0x42800000, v28
  v_cos_f32 v66, v66
  v_fract_f32 v48, v48
  v_fract_f32 v64, v64
  v_add_f32 v66, v66, v66
  v_add_f32 v56, v48, v64
  v_cos_f32 v64, v64
  v_fmamk_f32 v49, v28, 0x3f800000, v48
  v_fmamk_f32 v50, v28, 0x40000000, v48
  v_fmamk_f32 v51, v28, 0x40400000, v48
  v_cos_f32 v48, v48
  v_cos_f32 v49, v49
  v_cos_f32 v50, v50
  v_cos_f32_e64 v51, v51
  s_nop 0
  v_pk_fma_f32 v[52:53], v[50:51], v[66:67], v[48:49] op_sel_hi:[1,0,1] neg_lo:[0,0,1] neg_hi:[0,0,1]
  v_pk_fma_f32 v[54:55], v[52:53], v[66:67], v[50:51] op_sel_hi:[1,0,1] neg_lo:[0,0,1] neg_hi:[0,0,1]
  v_add_f32_e64 v64, v64, v64
  v_cvt_pk_bf16_f32 v20, v48, v49
  v_cvt_pk_bf16_f32 v21, v50, v51
  v_cvt_pk_bf16_f32 v22, v52, v53
  v_cvt_pk_bf16_f32 v23, v54, v55
  ds_write_b128 v14, v[20:23] offset:0
  v_fmamk_f32 v57, v28, 0x3f800000, v56
  v_fmamk_f32 v58, v28, 0x40000000, v56
  v_fmamk_f32 v59, v28, 0x40400000, v56
  v_cos_f32 v56, v56
  v_cos_f32 v57, v57
  v_cos_f32 v58, v58
  v_cos_f32_e64 v59, v59
  s_nop 0
  v_pk_fma_f32 v[60:61], v[58:59], v[66:67], v[56:57] op_sel_hi:[1,0,1] neg_lo:[0,0,1] neg_hi:[0,0,1]
  v_pk_fma_f32 v[62:63], v[60:61], v[66:67], v[58:59] op_sel_hi:[1,0,1] neg_lo:[0,0,1] neg_hi:[0,0,1]
  v_cvt_pk_bf16_f32 v24, v56, v57
  v_cvt_pk_bf16_f32 v25, v58, v59
  v_cvt_pk_bf16_f32 v26, v60, v61
  v_cvt_pk_bf16_f32 v27, v62, v63
  ds_write_b128 v14, v[24:27] offset:4096
  v_pk_fma_f32 v[48:49], v[56:57], v[64:65], v[48:49] op_sel_hi:[1,0,1] neg_lo:[0,0,1] neg_hi:[0,0,1]
  v_pk_fma_f32 v[50:51], v[58:59], v[64:65], v[50:51] op_sel_hi:[1,0,1] neg_lo:[0,0,1] neg_hi:[0,0,1]
  v_pk_fma_f32 v[52:53], v[60:61], v[64:65], v[52:53] op_sel_hi:[1,0,1] neg_lo:[0,0,1] neg_hi:[0,0,1]
  v_pk_fma_f32 v[54:55], v[62:63], v[64:65], v[54:55] op_sel_hi:[1,0,1] neg_lo:[0,0,1] neg_hi:[0,0,1]
  v_cvt_pk_bf16_f32 v20, v48, v49
  v_cvt_pk_bf16_f32 v21, v50, v51
  v_cvt_pk_bf16_f32 v22, v52, v53
  v_cvt_pk_bf16_f32 v23, v54, v55
  ds_write_b128 v14, v[20:23] offset:8192
  v_pk_fma_f32 v[56:57], v[48:49], v[64:65], v[56:57] op_sel_hi:[1,0,1] neg_lo:[0,0,1] neg_hi:[0,0,1]
  v_pk_fma_f32 v[58:59], v[50:51], v[64:65], v[58:59] op_sel_hi:[1,0,1] neg_lo:[0,0,1] neg_hi:[0,0,1]
  v_pk_fma_f32 v[60:61], v[52:53], v[64:65], v[60:61] op_sel_hi:[1,0,1] neg_lo:[0,0,1] neg_hi:[0,0,1]
  v_pk_fma_f32 v[62:63], v[54:55], v[64:65], v[62:63] op_sel_hi:[1,0,1] neg_lo:[0,0,1] neg_hi:[0,0,1]
  v_cvt_pk_bf16_f32 v24, v56, v57
  v_cvt_pk_bf16_f32 v25, v58, v59
  v_cvt_pk_bf16_f32 v26, v60, v61
  v_cvt_pk_bf16_f32 v27, v62, v63
  ds_write_b128 v14, v[24:27] offset:12288
  v_pk_fma_f32 v[48:49], v[56:57], v[64:65], v[48:49] op_sel_hi:[1,0,1] neg_lo:[0,0,1] neg_hi:[0,0,1]
  v_pk_fma_f32 v[50:51], v[58:59], v[64:65], v[50:51] op_sel_hi:[1,0,1] neg_lo:[0,0,1] neg_hi:[0,0,1]
  v_pk_fma_f32 v[52:53], v[60:61], v[64:65], v[52:53] op_sel_hi:[1,0,1] neg_lo:[0,0,1] neg_hi:[0,0,1]
  v_pk_fma_f32 v[54:55], v[62:63], v[64:65], v[54:55] op_sel_hi:[1,0,1] neg_lo:[0,0,1] neg_hi:[0,0,1]
  v_cvt_pk_bf16_f32 v20, v48, v49
  v_cvt_pk_bf16_f32 v21, v50, v51
  v_cvt_pk_bf16_f32 v22, v52, v53
  v_cvt_pk_bf16_f32 v23, v54, v55
  ds_write_b128 v14, v[20:23] offset:16384
  v_pk_fma_f32 v[56:57], v[48:49], v[64:65], v[56:57] op_sel_hi:[1,0,1] neg_lo:[0,0,1] neg_hi:[0,0,1]
  v_pk_fma_f32 v[58:59], v[50:51], v[64:65], v[58:59] op_sel_hi:[1,0,1] neg_lo:[0,0,1] neg_hi:[0,0,1]
  v_pk_fma_f32 v[60:61], v[52:53], v[64:65], v[60:61] op_sel_hi:[1,0,1] neg_lo:[0,0,1] neg_hi:[0,0,1]
  v_pk_fma_f32 v[62:63], v[54:55], v[64:65], v[62:63] op_sel_hi:[1,0,1] neg_lo:[0,0,1] neg_hi:[0,0,1]
  v_cvt_pk_bf16_f32 v24, v56, v57
  v_cvt_pk_bf16_f32 v25, v58, v59
L_pad14:
  v_cvt_pk_bf16_f32 v26, v60, v61
  v_cvt_pk_bf16_f32 v27, v62, v63
  ds_write_b128 v14, v[24:27] offset:20480
  v_pk_fma_f32 v[48:49], v[56:57], v[64:65], v[48:49] op_sel_hi:[1,0,1] neg_lo:[0,0,1] neg_hi:[0,0,1]
  v_pk_fma_f32 v[50:51], v[58:59], v[64:65], v[50:51] op_sel_hi:[1,0,1] neg_lo:[0,0,1] neg_hi:[0,0,1]
  v_pk_fma_f32 v[52:53], v[60:61], v[64:65], v[52:53] op_sel_hi:[1,0,1] neg_lo:[0,0,1] neg_hi:[0,0,1]
  v_pk_fma_f32 v[54:55], v[62:63], v[64:65], v[54:55] op_sel_hi:[1,0,1] neg_lo:[0,0,1] neg_hi:[0,0,1]
  v_cvt_pk_bf16_f32 v20, v48, v49
  v_cvt_pk_bf16_f32 v21, v50, v51
  v_cvt_pk_bf16_f32 v22, v52, v53
  v_cvt_pk_bf16_f32 v23, v54, v55
  ds_write_b128 v14, v[20:23] offset:24576
  v_pk_fma_f32 v[56:57], v[48:49], v[64:65], v[56:57] op_sel_hi:[1,0,1] neg_lo:[0,0,1] neg_hi:[0,0,1]
  v_pk_fma_f32 v[58:59], v[50:51], v[64:65], v[58:59] op_sel_hi:[1,0,1] neg_lo:[0,0,1] neg_hi:[0,0,1]
  v_pk_fma_f32 v[60:61], v[52:53], v[64:65], v[60:61] op_sel_hi:[1,0,1] neg_lo:[0,0,1] neg_hi:[0,0,1]
  v_pk_fma_f32 v[62:63], v[54:55], v[64:65], v[62:63] op_sel_hi:[1,0,1] neg_lo:[0,0,1] neg_hi:[0,0,1]
  v_cvt_pk_bf16_f32 v24, v56, v57
  v_cvt_pk_bf16_f32 v25, v58, v59
  v_cvt_pk_bf16_f32 v26, v60, v61
  v_cvt_pk_bf16_f32 v27, v62, v63
  ds_write_b128 v14, v[24:27] offset:28672
  v_pk_fma_f32 v[48:49], v[56:57], v[64:65], v[48:49] op_sel_hi:[1,0,1] neg_lo:[0,0,1] neg_hi:[0,0,1]
  v_pk_fma_f32 v[50:51], v[58:59], v[64:65], v[50:51] op_sel_hi:[1,0,1] neg_lo:[0,0,1] neg_hi:[0,0,1]
  v_pk_fma_f32 v[52:53], v[60:61], v[64:65], v[52:53] op_sel_hi:[1,0,1] neg_lo:[0,0,1] neg_hi:[0,0,1]
  v_pk_fma_f32 v[54:55], v[62:63], v[64:65], v[54:55] op_sel_hi:[1,0,1] neg_lo:[0,0,1] neg_hi:[0,0,1]
  v_cvt_pk_bf16_f32 v20, v48, v49
  v_cvt_pk_bf16_f32 v21, v50, v51
  v_cvt_pk_bf16_f32 v22, v52, v53
  v_cvt_pk_bf16_f32 v23, v54, v55
  ds_write_b128 v14, v[20:23] offset:32768
  s_add_u32 s45, s44, s4
  v_cvt_f32_u32_e64 v31, s45
  s_lshl_b32 s44, s56, 3
  v_add_lshl_u32 v32, v0, s44, 3
  v_mul_f32 v31, 0x3ae38e39, v31
  v_cvt_f32_u32 v32, v32
  v_add_f32 v66, v31, v31
  v_fma_f32 v32, v31, v32, s46
  v_cos_f32 v66, v66
  v_fract_f32 v32, v32
  v_and_b32 v5, 31, v0
  v_add_f32 v66, v66, v66
  v_fmamk_f32 v33, v31, 0x3f800000, v32
  v_fmamk_f32 v34, v31, 0x40000000, v32
  v_fmamk_f32 v35, v31, 0x40400000, v32
  v_cos_f32 v32, v32
  v_cos_f32 v33, v33
  v_cos_f32 v34, v34
  v_cos_f32_e64 v35, v35
  s_nop 0
  v_pk_fma_f32 v[36:37], v[34:35], v[66:67], v[32:33] op_sel_hi:[1,0,1] neg_lo:[0,0,1] neg_hi:[0,0,1]
  v_pk_fma_f32 v[38:39], v[36:37], v[66:67], v[34:35] op_sel_hi:[1,0,1] neg_lo:[0,0,1] neg_hi:[0,0,1]
  s_lshl_b32 s44, s44, 2
  s_add_u32 s44, s44, 256
  v_add_lshl_u32 v40, v5, s44, 1
  v_cvt_f32_u32 v40, v40
  s_mul_i32 s45, s4, 1184
  v_fma_f32 v40, v31, v40, s46
  s_add_u32 s45, s45, 157696
  v_fract_f32 v40, v40
  v_add_u32 v4, s45, v3
  v_add_f32 v41, v40, v31
  v_cos_f32 v40, v40
  v_cos_f32_e64 v41, v41
  v_cvt_pk_bf16_f32 v44, v32, v33
  v_cvt_pk_bf16_f32 v45, v34, v35
  v_cvt_pk_bf16_f32 v46, v36, v37
  v_cvt_pk_bf16_f32 v47, v38, v39
  ds_write_b128 v4, v[44:47]
  v_cvt_pk_bf16_f32 v40, v40, v41
  v_lshl_add_u32 v5, v5, 2, s45
  ds_write_b32 v5, v40 offset:1024
  s_barrier
  s_add_u32 m0, s84, 16384
  s_lshl_b32 s3, s57, 7
  buffer_load_dwordx4 v16, s[8:11], s3 offen offset:0 lds
  buffer_load_dwordx4 v17, s[8:11], s3 offen offset:1024 lds
  buffer_load_dwordx4 v18, s[8:11], s3 offen offset:2048 lds
  buffer_load_dwordx4 v19, s[8:11], s3 offen offset:3072 lds
  s_add_u32 s58, s56, 2
  s_sub_u32 s3, s58, 9
  s_min_u32 s58, s58, s3
  s_add_u32 s59, s56, 3
  s_sub_u32 s3, s59, 9
  s_min_u32 s59, s59, s3
  s_add_u32 s60, s56, 4
  s_sub_u32 s3, s60, 9
  s_min_u32 s60, s60, s3
  s_add_u32 s61, s56, 5
  s_sub_u32 s3, s61, 9
  s_min_u32 s61, s61, s3
  s_add_u32 s62, s56, 6
  s_sub_u32 s3, s62, 9
  s_min_u32 s62, s62, s3
  s_add_u32 s63, s56, 7
  s_sub_u32 s3, s63, 9
  s_min_u32 s63, s63, s3
  s_add_u32 s64, s56, 8
  s_sub_u32 s3, s64, 9
  s_min_u32 s64, s64, s3
  v_lshrrev_b32 v8, 1, v1
  v_xor_b32 v8, v8, v2
  v_lshlrev_b32 v8, 4, v8
  v_lshl_add_u32 v8, v1, 7, v8
  s_lshl_b32 s3, s4, 12
  v_add_u32 v8, s3, v8
  v_xor_b32 v9, 64, v8
  v_add_u32 v4, 11, v1
  v_lshrrev_b32_e64 v4, 4, v4
  v_mul_u32_u24 v5, 1184, v1
  v_lshl_add_u32 v5, v2, 4, v5
  v_lshl_add_u32 v5, v4, 18, v5
  v_add_u32 v108, 157696, v5
  v_and_b32 v4, 3, v1
  v_xor_b32 v5, v4, v2
  v_lshlrev_b32_e64 v5, 6, v5
  v_lshl_add_u32 v5, v4, 8, v5
  v_add_u32 v4, 1, v4
  v_lshrrev_b32 v4, 2, v4
  v_lshl_add_u32 v5, v4, 18, v5
  v_lshrrev_b32_e64 v4, 2, v1
  v_lshl_add_u32 v5, v4, 4, v5
  v_add_u32 v11, 102400, v5
  v_add_u32 v14, 65536, v3
  s_waitcnt lgkmcnt(0)
  s_waitcnt vmcnt(8)
  s_barrier
  s_setprio 1
  s_add_u32 m0, s84, 65536
  s_lshl_b32 s3, s58, 7
  s_waitcnt vmcnt(7)
  buffer_load_dwordx4 v16, s[8:11], s3 offen offset:0 lds
  s_waitcnt vmcnt(7)
  buffer_load_dwordx4 v17, s[8:11], s3 offen offset:1024 lds
  s_waitcnt vmcnt(7)
  buffer_load_dwordx4 v18, s[8:11], s3 offen offset:2048 lds
  s_waitcnt vmcnt(7)
  buffer_load_dwordx4 v19, s[8:11], s3 offen offset:3072 lds
  ds_read_b128 v[112:115], v8 offset:0
  ds_read_b128 v[116:119], v8 offset:2048
  ds_read_b128 v[120:123], v9 offset:0
  ds_read_b128 v[124:127], v9 offset:2048
  ds_read_b128 v[20:23], v10 offset:0
  ds_read_b128 v[24:27], v10 offset:1024
  ds_read_b128 v[28:31], v108 offset:0
  ds_read_b128 v[32:35], v10 offset:2048
  ds_read_b128 v[36:39], v10 offset:3072
  ds_read_b128 v[40:43], v108 offset:64
  ds_read_b128 v[44:47], v10 offset:4096
  ds_read_b128 v[48:51], v10 offset:5120
  ds_read_b128 v[52:55], v108 offset:128
  ds_read_b128 v[56:59], v10 offset:6144
  ds_read_b128 v[60:63], v10 offset:7168
  ds_read_b128 v[64:67], v108 offset:192
  s_add_u32 m0, s84, 81920
  s_lshl_b32 s3, s59, 7
  s_waitcnt vmcnt(7)
  buffer_load_dwordx4 v16, s[8:11], s3 offen offset:0 lds
  s_waitcnt vmcnt(7)
  buffer_load_dwordx4 v17, s[8:11], s3 offen offset:1024 lds
L_pad15:
  s_waitcnt vmcnt(7)
  buffer_load_dwordx4 v18, s[8:11], s3 offen offset:2048 lds
  s_waitcnt vmcnt(7)
  buffer_load_dwordx4 v19, s[8:11], s3 offen offset:3072 lds
  ds_read_b128 v[128:131], v8 offset:16384
  ds_read_b128 v[132:135], v8 offset:18432
  ds_read_b128 v[136:139], v9 offset:16384
  ds_read_b128 v[140:143], v9 offset:18432
  s_waitcnt lgkmcnt(10)
  v_mfma_f32_16x16x32_bf16 v[76:79], v[112:115], v[20:23], 0
  v_mfma_f32_16x16x32_bf16 v[80:83], v[116:119], v[20:23], 0
  ds_read_b128 v[20:23], v10 offset:8192
  v_mfma_f32_16x16x32_bf16 v[88:91], v[116:119], v[24:27], 0
  v_mfma_f32_16x16x32_bf16 v[84:87], v[112:115], v[24:27], 0
  ds_read_b128 v[24:27], v10 offset:9216
  v_mfma_f32_16x16x32_bf16 v[92:95], v[112:115], v[28:31], 0
  v_mfma_f32_16x16x32_bf16 v[96:99], v[116:119], v[28:31], 0
  ds_read_b128 v[28:31], v108 offset:256
  v_mfma_f32_16x16x32_bf16 v[76:79], v[120:123], v[32:35], v[76:79]
  v_mfma_f32_16x16x32_bf16 v[80:83], v[124:127], v[32:35], v[80:83]
  ds_read_b128 v[32:35], v10 offset:10240
  v_mfma_f32_16x16x32_bf16 v[88:91], v[124:127], v[36:39], v[88:91]
  v_mfma_f32_16x16x32_bf16 v[84:87], v[120:123], v[36:39], v[84:87]
  ds_read_b128 v[36:39], v10 offset:11264
  v_mfma_f32_16x16x32_bf16 v[92:95], v[120:123], v[40:43], v[92:95]
  v_mfma_f32_16x16x32_bf16 v[96:99], v[124:127], v[40:43], v[96:99]
  ds_read_b128 v[40:43], v108 offset:320
  s_barrier
  s_waitcnt lgkmcnt(6)
  v_mfma_f32_16x16x32_bf16 v[76:79], v[128:131], v[44:47], v[76:79]
  v_mfma_f32_16x16x32_bf16 v[80:83], v[132:135], v[44:47], v[80:83]
  ds_read_b128 v[44:47], v10 offset:12288
  s_add_u32 m0, s84, 98304
  s_lshl_b32 s3, s60, 7
  s_waitcnt vmcnt(7)
  buffer_load_dwordx4 v16, s[8:11], s3 offen offset:0 lds
  v_mfma_f32_16x16x32_bf16 v[88:91], v[132:135], v[48:51], v[88:91]
  v_mfma_f32_16x16x32_bf16 v[84:87], v[128:131], v[48:51], v[84:87]
  ds_read_b128 v[48:51], v10 offset:13312
  v_mfma_f32_16x16x32_bf16 v[92:95], v[128:131], v[52:55], v[92:95]
  v_mfma_f32_16x16x32_bf16 v[96:99], v[132:135], v[52:55], v[96:99]
  ds_read_b128 v[52:55], v108 offset:384
  s_waitcnt vmcnt(7)
  buffer_load_dwordx4 v17, s[8:11], s3 offen offset:1024 lds
  v_mfma_f32_16x16x32_bf16 v[76:79], v[136:139], v[56:59], v[76:79]
  v_mfma_f32_16x16x32_bf16 v[80:83], v[140:143], v[56:59], v[80:83]
  ds_read_b128 v[56:59], v10 offset:14336
  s_waitcnt vmcnt(7)
  buffer_load_dwordx4 v18, s[8:11], s3 offen offset:2048 lds
  v_mfma_f32_16x16x32_bf16 v[88:91], v[140:143], v[60:63], v[88:91]
  v_mfma_f32_16x16x32_bf16 v[84:87], v[136:139], v[60:63], v[84:87]
  ds_read_b128 v[60:63], v10 offset:15360
  v_mfma_f32_16x16x32_bf16 v[92:95], v[136:139], v[64:67], v[92:95]
  v_mfma_f32_16x16x32_bf16 v[96:99], v[140:143], v[64:67], v[96:99]
  ds_read_b128 v[64:67], v108 offset:448
  s_waitcnt vmcnt(7)
  buffer_load_dwordx4 v19, s[8:11], s3 offen offset:3072 lds
  s_barrier
  v_xor_b32 v8, 0x10000, v8
  v_xor_b32 v9, 0x10000, v9
  ds_read_b128 v[144:147], v8 offset:0
  ds_read_b128 v[148:151], v8 offset:2048
  ds_read_b128 v[152:155], v9 offset:0
  ds_read_b128 v[156:159], v9 offset:2048
  s_add_u32 m0, s84, 32768
  s_lshl_b32 s3, s61, 7
  s_waitcnt vmcnt(7)
  buffer_load_dwordx4 v16, s[8:11], s3 offen offset:0 lds
  s_waitcnt vmcnt(7)
  buffer_load_dwordx4 v17, s[8:11], s3 offen offset:1024 lds
  s_waitcnt vmcnt(7)
  buffer_load_dwordx4 v18, s[8:11], s3 offen offset:2048 lds
  s_waitcnt vmcnt(7)
  buffer_load_dwordx4 v19, s[8:11], s3 offen offset:3072 lds
  ds_read_b128 v[160:163], v8 offset:16384
  ds_read_b128 v[164:167], v8 offset:18432
  ds_read_b128 v[168:171], v9 offset:16384
  ds_read_b128 v[172:175], v9 offset:18432
  s_waitcnt lgkmcnt(4)
  v_mfma_f32_16x16x32_bf16 v[76:79], v[144:147], v[20:23], v[76:79]
  v_mfma_f32_16x16x32_bf16 v[80:83], v[148:151], v[20:23], v[80:83]
  ds_read_b128 v[20:23], v10 offset:16384
  s_add_u32 m0, s84, 49152
  s_lshl_b32 s3, s62, 7
  s_waitcnt vmcnt(7)
  buffer_load_dwordx4 v16, s[8:11], s3 offen offset:0 lds
  v_mfma_f32_16x16x32_bf16 v[88:91], v[148:151], v[24:27], v[88:91]
  v_mfma_f32_16x16x32_bf16 v[84:87], v[144:147], v[24:27], v[84:87]
  ds_read_b128 v[24:27], v10 offset:17408
  v_mfma_f32_16x16x32_bf16 v[92:95], v[144:147], v[28:31], v[92:95]
  v_mfma_f32_16x16x32_bf16 v[96:99], v[148:151], v[28:31], v[96:99]
  ds_read_b128 v[28:31], v108 offset:512
  s_waitcnt vmcnt(7)
  buffer_load_dwordx4 v17, s[8:11], s3 offen offset:1024 lds
  v_mfma_f32_16x16x32_bf16 v[76:79], v[152:155], v[32:35], v[76:79]
  v_mfma_f32_16x16x32_bf16 v[80:83], v[156:159], v[32:35], v[80:83]
  ds_read_b128 v[32:35], v10 offset:18432
  s_waitcnt vmcnt(7)
  buffer_load_dwordx4 v18, s[8:11], s3 offen offset:2048 lds
  v_mfma_f32_16x16x32_bf16 v[88:91], v[156:159], v[36:39], v[88:91]
  v_mfma_f32_16x16x32_bf16 v[84:87], v[152:155], v[36:39], v[84:87]
  ds_read_b128 v[36:39], v10 offset:19456
  v_mfma_f32_16x16x32_bf16 v[92:95], v[152:155], v[40:43], v[92:95]
  v_mfma_f32_16x16x32_bf16 v[96:99], v[156:159], v[40:43], v[96:99]
  ds_read_b128 v[40:43], v108 offset:576
  s_waitcnt vmcnt(7)
  buffer_load_dwordx4 v19, s[8:11], s3 offen offset:3072 lds
  s_barrier
  ds_read_b128 v[176:179], v8 offset:32768
  ds_read_b128 v[180:183], v8 offset:34816
  ds_read_b128 v[184:187], v9 offset:32768
  ds_read_b128 v[188:191], v9 offset:34816
  s_waitcnt lgkmcnt(10)
  v_mfma_f32_16x16x32_bf16 v[76:79], v[160:163], v[44:47], v[76:79]
  v_mfma_f32_16x16x32_bf16 v[80:83], v[164:167], v[44:47], v[80:83]
  ds_read_b128 v[44:47], v10 offset:20480
  s_add_u32 m0, s84, 0
  s_lshl_b32 s3, s63, 7
  s_waitcnt vmcnt(7)
  buffer_load_dwordx4 v16, s[8:11], s3 offen offset:0 lds
  v_mfma_f32_16x16x32_bf16 v[88:91], v[164:167], v[48:51], v[88:91]
  v_mfma_f32_16x16x32_bf16 v[84:87], v[160:163], v[48:51], v[84:87]
  ds_read_b128 v[48:51], v10 offset:21504
  v_mfma_f32_16x16x32_bf16 v[92:95], v[160:163], v[52:55], v[92:95]
  v_mfma_f32_16x16x32_bf16 v[96:99], v[164:167], v[52:55], v[96:99]
  ds_read_b128 v[52:55], v108 offset:640
  s_waitcnt vmcnt(7)
  buffer_load_dwordx4 v17, s[8:11], s3 offen offset:1024 lds
  v_mfma_f32_16x16x32_bf16 v[76:79], v[168:171], v[56:59], v[76:79]
  v_mfma_f32_16x16x32_bf16 v[80:83], v[172:175], v[56:59], v[80:83]
  ds_read_b128 v[56:59], v10 offset:22528
  s_waitcnt vmcnt(7)
  buffer_load_dwordx4 v18, s[8:11], s3 offen offset:2048 lds
  v_mfma_f32_16x16x32_bf16 v[88:91], v[172:175], v[60:63], v[88:91]
  v_mfma_f32_16x16x32_bf16 v[84:87], v[168:171], v[60:63], v[84:87]
  ds_read_b128 v[60:63], v10 offset:23552
  v_mfma_f32_16x16x32_bf16 v[92:95], v[168:171], v[64:67], v[92:95]
  v_mfma_f32_16x16x32_bf16 v[96:99], v[172:175], v[64:67], v[96:99]
  ds_read_b128 v[64:67], v108 offset:704
  s_waitcnt vmcnt(7)
  buffer_load_dwordx4 v19, s[8:11], s3 offen offset:3072 lds
  v_xor_b32 v8, 0x10000, v8
  v_xor_b32 v9, 0x10000, v9
L_pad16:
  s_cbranch_execz L_retack
  ds_read_b128 v[192:195], v8 offset:32768
  ds_read_b128 v[196:199], v8 offset:34816
  ds_read_b128 v[200:203], v9 offset:32768
  ds_read_b128 v[204:207], v9 offset:34816
  s_waitcnt lgkmcnt(10)
  v_mfma_f32_16x16x32_bf16 v[76:79], v[176:179], v[20:23], v[76:79]
  v_mfma_f32_16x16x32_bf16 v[80:83], v[180:183], v[20:23], v[80:83]
  ds_read_b128 v[20:23], v10 offset:24576
  s_add_u32 m0, s84, 16384
  s_lshl_b32 s3, s64, 7
  s_waitcnt vmcnt(7)
  buffer_load_dwordx4 v16, s[8:11], s3 offen offset:0 lds
  v_mfma_f32_16x16x32_bf16 v[88:91], v[180:183], v[24:27], v[88:91]
  v_mfma_f32_16x16x32_bf16 v[84:87], v[176:179], v[24:27], v[84:87]
  ds_read_b128 v[24:27], v10 offset:25600
  v_mfma_f32_16x16x32_bf16 v[92:95], v[176:179], v[28:31], v[92:95]
  v_mfma_f32_16x16x32_bf16 v[96:99], v[180:183], v[28:31], v[96:99]
  ds_read_b128 v[28:31], v108 offset:768
  s_waitcnt vmcnt(7)
  buffer_load_dwordx4 v17, s[8:11], s3 offen offset:1024 lds
  v_mfma_f32_16x16x32_bf16 v[76:79], v[184:187], v[32:35], v[76:79]
  v_mfma_f32_16x16x32_bf16 v[80:83], v[188:191], v[32:35], v[80:83]
  ds_read_b128 v[32:35], v10 offset:26624
  s_waitcnt vmcnt(7)
  buffer_load_dwordx4 v18, s[8:11], s3 offen offset:2048 lds
  v_mfma_f32_16x16x32_bf16 v[88:91], v[188:191], v[36:39], v[88:91]
  v_mfma_f32_16x16x32_bf16 v[84:87], v[184:187], v[36:39], v[84:87]
  ds_read_b128 v[36:39], v10 offset:27648
  v_mfma_f32_16x16x32_bf16 v[92:95], v[184:187], v[40:43], v[92:95]
  v_mfma_f32_16x16x32_bf16 v[96:99], v[188:191], v[40:43], v[96:99]
  ds_read_b128 v[40:43], v108 offset:832
  s_waitcnt vmcnt(7)
  buffer_load_dwordx4 v19, s[8:11], s3 offen offset:3072 lds
  s_barrier
  ds_read_b128 v[208:211], v8 offset:49152
  ds_read_b128 v[212:215], v8 offset:51200
  ds_read_b128 v[216:219], v9 offset:49152
  ds_read_b128 v[220:223], v9 offset:51200
  s_waitcnt lgkmcnt(10)
  v_mfma_f32_16x16x32_bf16 v[76:79], v[192:195], v[44:47], v[76:79]
  v_mfma_f32_16x16x32_bf16 v[80:83], v[196:199], v[44:47], v[80:83]
  ds_read_b128 v[44:47], v10 offset:28672
  v_mfma_f32_16x16x32_bf16 v[88:91], v[196:199], v[48:51], v[88:91]
  v_mfma_f32_16x16x32_bf16 v[84:87], v[192:195], v[48:51], v[84:87]
  ds_read_b128 v[48:51], v10 offset:29696
  v_mfma_f32_16x16x32_bf16 v[92:95], v[192:195], v[52:55], v[92:95]
  v_mfma_f32_16x16x32_bf16 v[96:99], v[196:199], v[52:55], v[96:99]
  ds_read_b128 v[52:55], v108 offset:896
  v_mfma_f32_16x16x32_bf16 v[76:79], v[200:203], v[56:59], v[76:79]
  v_mfma_f32_16x16x32_bf16 v[80:83], v[204:207], v[56:59], v[80:83]
  ds_read_b128 v[56:59], v10 offset:30720
  v_mfma_f32_16x16x32_bf16 v[88:91], v[204:207], v[60:63], v[88:91]
  v_mfma_f32_16x16x32_bf16 v[84:87], v[200:203], v[60:63], v[84:87]
  ds_read_b128 v[60:63], v10 offset:31744
  v_mfma_f32_16x16x32_bf16 v[92:95], v[200:203], v[64:67], v[92:95]
  v_mfma_f32_16x16x32_bf16 v[96:99], v[204:207], v[64:67], v[96:99]
  ds_read_b128 v[64:67], v108 offset:960
  s_waitcnt vmcnt(4)
  ds_read_b128 v[224:227], v8 offset:0
  ds_read_b128 v[228:231], v8 offset:2048
  ds_read_b128 v[232:235], v9 offset:0
  ds_read_b128 v[236:239], v9 offset:2048
  s_waitcnt lgkmcnt(10)
  v_mfma_f32_16x16x32_bf16 v[76:79], v[208:211], v[20:23], v[76:79]
  v_mfma_f32_16x16x32_bf16 v[80:83], v[212:215], v[20:23], v[80:83]
  ds_read_b128 v[20:23], v10 offset:32768
  v_mfma_f32_16x16x32_bf16 v[88:91], v[212:215], v[24:27], v[88:91]
  v_mfma_f32_16x16x32_bf16 v[84:87], v[208:211], v[24:27], v[84:87]
  ds_read_b128 v[24:27], v10 offset:33792
  v_mfma_f32_16x16x32_bf16 v[92:95], v[208:211], v[28:31], v[92:95]
  v_mfma_f32_16x16x32_bf16 v[96:99], v[212:215], v[28:31], v[96:99]
  ds_read_b128 v[28:31], v108 offset:1024
  v_mfma_f32_16x16x32_bf16 v[76:79], v[216:219], v[32:35], v[76:79]
  v_mfma_f32_16x16x32_bf16 v[80:83], v[220:223], v[32:35], v[80:83]
  ds_read_b128 v[32:35], v10 offset:34816
  v_mfma_f32_16x16x32_bf16 v[88:91], v[220:223], v[36:39], v[88:91]
  v_mfma_f32_16x16x32_bf16 v[84:87], v[216:219], v[36:39], v[84:87]
  ds_read_b128 v[36:39], v10 offset:35840
  v_mfma_f32_16x16x32_bf16 v[92:95], v[216:219], v[40:43], v[92:95]
  v_mfma_f32_16x16x32_bf16 v[96:99], v[220:223], v[40:43], v[96:99]
  ds_read_b128 v[40:43], v108 offset:1088
  s_waitcnt lgkmcnt(6)
  v_mfma_f32_16x16x32_bf16 v[76:79], v[224:227], v[44:47], v[76:79]
  v_mfma_f32_16x16x32_bf16 v[80:83], v[228:231], v[44:47], v[80:83]
  v_mfma_f32_16x16x32_bf16 v[88:91], v[228:231], v[48:51], v[88:91]
  v_mfma_f32_16x16x32_bf16 v[84:87], v[224:227], v[48:51], v[84:87]
  v_mfma_f32_16x16x32_bf16 v[92:95], v[224:227], v[52:55], v[92:95]
  v_mfma_f32_16x16x32_bf16 v[96:99], v[228:231], v[52:55], v[96:99]
  v_mfma_f32_16x16x32_bf16 v[76:79], v[232:235], v[56:59], v[76:79]
  v_mfma_f32_16x16x32_bf16 v[80:83], v[236:239], v[56:59], v[80:83]
  v_mfma_f32_16x16x32_bf16 v[88:91], v[236:239], v[60:63], v[88:91]
  v_mfma_f32_16x16x32_bf16 v[84:87], v[232:235], v[60:63], v[84:87]
  v_mfma_f32_16x16x32_bf16 v[92:95], v[232:235], v[64:67], v[92:95]
  v_mfma_f32_16x16x32_bf16 v[96:99], v[236:239], v[64:67], v[96:99]
  s_waitcnt vmcnt(0)
  ds_read_b128 v[240:243], v8 offset:16384
  ds_read_b128 v[244:247], v8 offset:18432
  ds_read_b128 v[248:251], v9 offset:16384
  ds_read_b128 v[252:255], v9 offset:18432
  s_barrier
  s_waitcnt lgkmcnt(0)
  v_mfma_f32_16x16x32_bf16 v[76:79], v[240:243], v[20:23], v[76:79]
  v_mfma_f32_16x16x32_bf16 v[80:83], v[244:247], v[20:23], v[80:83]
  v_mfma_f32_16x16x32_bf16 v[88:91], v[244:247], v[24:27], v[88:91]
  v_mfma_f32_16x16x32_bf16 v[84:87], v[240:243], v[24:27], v[84:87]
  v_mfma_f32_16x16x32_bf16 v[92:95], v[240:243], v[28:31], v[92:95]
  v_mfma_f32_16x16x32_bf16 v[96:99], v[244:247], v[28:31], v[96:99]
  v_mfma_f32_16x16x32_bf16 v[76:79], v[248:251], v[32:35], v[76:79]
  v_mfma_f32_16x16x32_bf16 v[80:83], v[252:255], v[32:35], v[80:83]
  v_mfma_f32_16x16x32_bf16 v[88:91], v[252:255], v[36:39], v[88:91]
  v_mfma_f32_16x16x32_bf16 v[84:87], v[248:251], v[36:39], v[84:87]
  v_mfma_f32_16x16x32_bf16 v[92:95], v[248:251], v[40:43], v[92:95]
  v_mfma_f32_16x16x32_bf16 v[96:99], v[252:255], v[40:43], v[96:99]
  s_waitcnt lgkmcnt(0)
  s_barrier
  ds_read_b128 v[40:43], v14 offset:0
  ds_read_b128 v[44:47], v14 offset:1024
  ds_read_b128 v[48:51], v11 offset:0
  ds_read_b128 v[52:55], v14 offset:2048
  ds_read_b128 v[56:59], v14 offset:3072
  ds_read_b128 v[60:63], v11 offset:1024
  s_waitcnt lgkmcnt(3)
  v_mfma_f32_16x16x32_bf16 v[16:19], v[40:43], v[112:115], 0
  ds_read_b128 v[64:67], v14 offset:4096
  v_mfma_f32_16x16x32_bf16 v[28:31], v[40:43], v[116:119], 0
  ds_read_b128 v[68:71], v14 offset:5120
  v_mfma_f32_16x16x32_bf16 v[32:35], v[44:47], v[116:119], 0
  ds_read_b128 v[72:75], v11 offset:2048
  v_mfma_f32_16x16x32_bf16 v[20:23], v[44:47], v[112:115], 0
  v_cvt_pk_bf16_f32 v76, v76, v77
  v_cvt_pk_bf16_f32 v77, v78, v79
  v_mfma_f32_16x16x32_bf16 v[24:27], v[48:51], v[112:115], 0
  v_cvt_pk_bf16_f32 v78, v80, v81
  v_cvt_pk_bf16_f32 v79, v82, v83
  v_mfma_f32_16x16x32_bf16 v[36:39], v[48:51], v[116:119], 0
  v_cvt_pk_bf16_f32 v80, v84, v85
L_pad17:
  v_cvt_pk_bf16_f32 v81, v86, v87
  s_waitcnt lgkmcnt(3)
  v_mfma_f32_16x16x32_bf16 v[16:19], v[52:55], v[120:123], v[16:19]
  ds_read_b128 v[40:43], v14 offset:6144
  v_mfma_f32_16x16x32_bf16 v[28:31], v[52:55], v[124:127], v[28:31]
  ds_read_b128 v[44:47], v14 offset:7168
  v_mfma_f32_16x16x32_bf16 v[32:35], v[56:59], v[124:127], v[32:35]
  ds_read_b128 v[48:51], v11 offset:3072
  v_mfma_f32_16x16x32_bf16 v[20:23], v[56:59], v[120:123], v[20:23]
  v_cvt_pk_bf16_f32 v82, v88, v89
  v_cvt_pk_bf16_f32 v83, v90, v91
  v_mfma_f32_16x16x32_bf16 v[24:27], v[60:63], v[120:123], v[24:27]
  v_cvt_pk_bf16_f32 v84, v92, v93
  v_cvt_pk_bf16_f32 v85, v94, v95
  v_mfma_f32_16x16x32_bf16 v[36:39], v[60:63], v[124:127], v[36:39]
  v_cvt_pk_bf16_f32 v86, v96, v97
  v_cvt_pk_bf16_f32 v87, v98, v99
  s_waitcnt lgkmcnt(3)
  v_mfma_f32_16x16x32_bf16 v[16:19], v[64:67], v[128:131], v[16:19]
  s_barrier
  ds_read_b128 v[52:55], v14 offset:8192
  v_mfma_f32_16x16x32_bf16 v[28:31], v[64:67], v[132:135], v[28:31]
  ds_read_b128 v[56:59], v14 offset:9216
  v_mfma_f32_16x16x32_bf16 v[32:35], v[68:71], v[132:135], v[32:35]
  ds_read_b128 v[60:63], v11 offset:4096
  v_mfma_f32_16x16x32_bf16 v[20:23], v[68:71], v[128:131], v[20:23]
  v_and_b32 v4, 31, v0
  v_mul_u32_u24 v4, 160, v4
  v_mfma_f32_16x16x32_bf16 v[24:27], v[72:75], v[128:131], v[24:27]
  v_lshrrev_b32_e64 v5, 5, v0
  v_mul_u32_u24 v5, 80, v5
  v_mfma_f32_16x16x32_bf16 v[36:39], v[72:75], v[132:135], v[36:39]
  s_mul_i32 s45, s4, 5120
  s_add_u32 s45, s45, 36864
  s_waitcnt lgkmcnt(3)
  v_mfma_f32_16x16x32_bf16 v[16:19], v[40:43], v[136:139], v[16:19]
  ds_read_b128 v[64:67], v14 offset:10240
  v_mfma_f32_16x16x32_bf16 v[28:31], v[40:43], v[140:143], v[28:31]
  ds_read_b128 v[68:71], v14 offset:11264
  v_mfma_f32_16x16x32_bf16 v[32:35], v[44:47], v[140:143], v[32:35]
  ds_read_b128 v[72:75], v11 offset:5120
  v_mfma_f32_16x16x32_bf16 v[20:23], v[44:47], v[136:139], v[20:23]
  v_add3_u32 v12, v4, v5, s45
  s_mov_b32 s88, 0x3fb8aa3b
  v_mfma_f32_16x16x32_bf16 v[24:27], v[48:51], v[136:139], v[24:27]
  s_mov_b32 s89, 0x3fb8aa3b
  s_mul_i32 s45, s4, 3072
  v_mfma_f32_16x16x32_bf16 v[36:39], v[48:51], v[140:143], v[36:39]
  s_add_u32 s45, s45, 102400
  v_add_u32_e64 v109, s45, v3
  s_waitcnt lgkmcnt(3)
  v_mfma_f32_16x16x32_bf16 v[16:19], v[52:55], v[144:147], v[16:19]
  ds_read_b128 v[40:43], v14 offset:12288
  v_mfma_f32_16x16x32_bf16 v[28:31], v[52:55], v[148:151], v[28:31]
  ds_read_b128 v[44:47], v14 offset:13312
  v_mfma_f32_16x16x32_bf16 v[32:35], v[56:59], v[148:151], v[32:35]
  ds_read_b128 v[48:51], v11 offset:6144
  v_mfma_f32_16x16x32_bf16 v[20:23], v[56:59], v[144:147], v[20:23]
  v_lshrrev_b32 v4, 2, v1
  v_lshlrev_b32 v4, 8, v4
  v_mfma_f32_16x16x32_bf16 v[24:27], v[60:63], v[144:147], v[24:27]
  v_and_b32_e64 v5, 1, v2
  v_lshl_add_u32 v4, v5, 3, v4
  v_mfma_f32_16x16x32_bf16 v[36:39], v[60:63], v[148:151], v[36:39]
  v_and_b32_e64 v5, 3, v1
  v_lshl_add_u32 v4, v5, 1, v4
  s_waitcnt lgkmcnt(3)
  v_mfma_f32_16x16x32_bf16 v[16:19], v[64:67], v[152:155], v[16:19]
  ds_read_b128 v[52:55], v14 offset:14336
  v_mfma_f32_16x16x32_bf16 v[28:31], v[64:67], v[156:159], v[28:31]
  ds_read_b128 v[56:59], v14 offset:15360
  v_mfma_f32_16x16x32_bf16 v[32:35], v[68:71], v[156:159], v[32:35]
  ds_read_b128 v[60:63], v11 offset:7168
  v_mfma_f32_16x16x32_bf16 v[20:23], v[68:71], v[152:155], v[20:23]
  v_add_u32_e64 v13, s45, v4
  s_and_b32 s45, s7, 7
  v_mfma_f32_16x16x32_bf16 v[24:27], v[72:75], v[152:155], v[24:27]
  s_mul_i32 s45, s45, 82944
  s_add_u32 s45, s45, 9437184
  v_mfma_f32_16x16x32_bf16 v[36:39], v[72:75], v[156:159], v[36:39]
  s_add_u32 s24, s40, s45
  s_addc_u32 s25, s41, 0
  s_waitcnt lgkmcnt(3)
  v_mfma_f32_16x16x32_bf16 v[16:19], v[40:43], v[160:163], v[16:19]
  s_barrier
  ds_read_b128 v[64:67], v14 offset:16384
  v_mfma_f32_16x16x32_bf16 v[28:31], v[40:43], v[164:167], v[28:31]
  ds_read_b128 v[68:71], v14 offset:17408
  v_mfma_f32_16x16x32_bf16 v[32:35], v[44:47], v[164:167], v[32:35]
  ds_read_b128 v[72:75], v11 offset:8192
  v_mfma_f32_16x16x32_bf16 v[20:23], v[44:47], v[160:163], v[20:23]
  s_mov_b32 s26, 82944
  s_mov_b32 s27, 0x20000
  v_mfma_f32_16x16x32_bf16 v[24:27], v[48:51], v[160:163], v[24:27]
  s_lshl_b32 s84, s4, 10
  s_and_b32 s46, s7, 7
  v_mfma_f32_16x16x32_bf16 v[36:39], v[48:51], v[164:167], v[36:39]
  s_lshl_b32 s46, s46, 3
  s_and_b32 s45, s2, 7
  s_waitcnt lgkmcnt(3)
  v_mfma_f32_16x16x32_bf16 v[16:19], v[52:55], v[168:171], v[16:19]
  ds_read_b128 v[40:43], v14 offset:18432
  v_mfma_f32_16x16x32_bf16 v[28:31], v[52:55], v[172:175], v[28:31]
  ds_read_b128 v[44:47], v14 offset:19456
  v_mfma_f32_16x16x32_bf16 v[32:35], v[56:59], v[172:175], v[32:35]
  ds_read_b128 v[48:51], v11 offset:9216
  v_mfma_f32_16x16x32_bf16 v[20:23], v[56:59], v[168:171], v[20:23]
  s_add_u32 s46, s46, s45
  s_mul_i32 s46, s46, 1152
  v_mfma_f32_16x16x32_bf16 v[24:27], v[60:63], v[168:171], v[24:27]
  s_add_u32 s46, s46, 7929868
  v_mov_b32 v100, 0x42a00000
  v_mfma_f32_16x16x32_bf16 v[36:39], v[60:63], v[172:175], v[36:39]
  v_mov_b32 v95, 0x3f80
  s_waitcnt lgkmcnt(3)
  v_mfma_f32_16x16x32_bf16 v[16:19], v[64:67], v[176:179], v[16:19]
  ds_read_b128 v[52:55], v14 offset:20480
  v_mfma_f32_16x16x32_bf16 v[28:31], v[64:67], v[180:183], v[28:31]
  ds_read_b128 v[56:59], v14 offset:21504
  v_mfma_f32_16x16x32_bf16 v[32:35], v[68:71], v[180:183], v[32:35]
  ds_read_b128 v[60:63], v11 offset:10240
  v_mfma_f32_16x16x32_bf16 v[20:23], v[68:71], v[176:179], v[20:23]
  v_mfma_f32_16x16x32_bf16 v[24:27], v[72:75], v[176:179], v[24:27]
  v_mfma_f32_16x16x32_bf16 v[36:39], v[72:75], v[180:183], v[36:39]
  s_waitcnt lgkmcnt(3)
  v_mfma_f32_16x16x32_bf16 v[16:19], v[40:43], v[184:187], v[16:19]
  ds_read_b128 v[64:67], v14 offset:22528
  v_mfma_f32_16x16x32_bf16 v[28:31], v[40:43], v[188:191], v[28:31]
  ds_read_b128 v[68:71], v14 offset:23552
  v_mfma_f32_16x16x32_bf16 v[32:35], v[44:47], v[188:191], v[32:35]
  ds_read_b128 v[72:75], v11 offset:11264
  v_mfma_f32_16x16x32_bf16 v[20:23], v[44:47], v[184:187], v[20:23]
  v_mfma_f32_16x16x32_bf16 v[24:27], v[48:51], v[184:187], v[24:27]
  v_mfma_f32_16x16x32_bf16 v[36:39], v[48:51], v[188:191], v[36:39]
  s_waitcnt lgkmcnt(3)
  v_mfma_f32_16x16x32_bf16 v[16:19], v[52:55], v[192:195], v[16:19]
  s_barrier
  ds_read_b128 v[40:43], v14 offset:24576
  v_mfma_f32_16x16x32_bf16 v[28:31], v[52:55], v[196:199], v[28:31]
  ds_read_b128 v[44:47], v14 offset:25600
L_pad18:
  v_mfma_f32_16x16x32_bf16 v[32:35], v[56:59], v[196:199], v[32:35]
  ds_read_b128 v[48:51], v11 offset:12288
  v_mfma_f32_16x16x32_bf16 v[20:23], v[56:59], v[192:195], v[20:23]
  v_mfma_f32_16x16x32_bf16 v[24:27], v[60:63], v[192:195], v[24:27]
  v_mfma_f32_16x16x32_bf16 v[36:39], v[60:63], v[196:199], v[36:39]
  s_waitcnt lgkmcnt(3)
  v_mfma_f32_16x16x32_bf16 v[16:19], v[64:67], v[200:203], v[16:19]
  ds_read_b128 v[52:55], v14 offset:26624
  v_mfma_f32_16x16x32_bf16 v[28:31], v[64:67], v[204:207], v[28:31]
  ds_read_b128 v[56:59], v14 offset:27648
  v_mfma_f32_16x16x32_bf16 v[32:35], v[68:71], v[204:207], v[32:35]
  ds_read_b128 v[60:63], v11 offset:13312
  v_mfma_f32_16x16x32_bf16 v[20:23], v[68:71], v[200:203], v[20:23]
  v_mfma_f32_16x16x32_bf16 v[24:27], v[72:75], v[200:203], v[24:27]
  v_mfma_f32_16x16x32_bf16 v[36:39], v[72:75], v[204:207], v[36:39]
  s_waitcnt lgkmcnt(3)
  v_mfma_f32_16x16x32_bf16 v[16:19], v[40:43], v[208:211], v[16:19]
  ds_read_b128 v[64:67], v14 offset:28672
  v_mfma_f32_16x16x32_bf16 v[28:31], v[40:43], v[212:215], v[28:31]
  ds_read_b128 v[68:71], v14 offset:29696
  v_mfma_f32_16x16x32_bf16 v[32:35], v[44:47], v[212:215], v[32:35]
  ds_read_b128 v[72:75], v11 offset:14336
  v_mfma_f32_16x16x32_bf16 v[20:23], v[44:47], v[208:211], v[20:23]
  v_mfma_f32_16x16x32_bf16 v[24:27], v[48:51], v[208:211], v[24:27]
  v_mfma_f32_16x16x32_bf16 v[36:39], v[48:51], v[212:215], v[36:39]
  s_waitcnt lgkmcnt(3)
  v_mfma_f32_16x16x32_bf16 v[16:19], v[52:55], v[216:219], v[16:19]
  ds_read_b128 v[40:43], v14 offset:30720
  v_mfma_f32_16x16x32_bf16 v[28:31], v[52:55], v[220:223], v[28:31]
  ds_read_b128 v[44:47], v14 offset:31744
  v_mfma_f32_16x16x32_bf16 v[32:35], v[56:59], v[220:223], v[32:35]
  ds_read_b128 v[48:51], v11 offset:15360
  v_mfma_f32_16x16x32_bf16 v[20:23], v[56:59], v[216:219], v[20:23]
  v_mfma_f32_16x16x32_bf16 v[24:27], v[60:63], v[216:219], v[24:27]
  v_mfma_f32_16x16x32_bf16 v[36:39], v[60:63], v[220:223], v[36:39]
  s_waitcnt lgkmcnt(3)
  v_mfma_f32_16x16x32_bf16 v[16:19], v[64:67], v[224:227], v[16:19]
  ds_read_b128 v[52:55], v14 offset:32768
  v_mfma_f32_16x16x32_bf16 v[28:31], v[64:67], v[228:231], v[28:31]
  ds_read_b128 v[56:59], v14 offset:33792
  v_mfma_f32_16x16x32_bf16 v[32:35], v[68:71], v[228:231], v[32:35]
  ds_read_b128 v[60:63], v11 offset:16384
  v_mfma_f32_16x16x32_bf16 v[20:23], v[68:71], v[224:227], v[20:23]
  v_mfma_f32_16x16x32_bf16 v[24:27], v[72:75], v[224:227], v[24:27]
  v_mfma_f32_16x16x32_bf16 v[36:39], v[72:75], v[228:231], v[36:39]
  s_waitcnt lgkmcnt(3)
  v_mfma_f32_16x16x32_bf16 v[16:19], v[40:43], v[232:235], v[16:19]
  ds_read_b128 v[64:67], v14 offset:34816
  v_mfma_f32_16x16x32_bf16 v[28:31], v[40:43], v[236:239], v[28:31]
  ds_read_b128 v[68:71], v14 offset:35840
  v_mfma_f32_16x16x32_bf16 v[32:35], v[44:47], v[236:239], v[32:35]
  ds_read_b128 v[72:75], v11 offset:17408
  v_mfma_f32_16x16x32_bf16 v[20:23], v[44:47], v[232:235], v[20:23]
  v_mfma_f32_16x16x32_bf16 v[24:27], v[48:51], v[232:235], v[24:27]
  v_mfma_f32_16x16x32_bf16 v[36:39], v[48:51], v[236:239], v[36:39]
  s_waitcnt lgkmcnt(3)
  v_mfma_f32_16x16x32_bf16 v[16:19], v[52:55], v[240:243], v[16:19]
  v_mfma_f32_16x16x32_bf16 v[28:31], v[52:55], v[244:247], v[28:31]
  v_mfma_f32_16x16x32_bf16 v[32:35], v[56:59], v[244:247], v[32:35]
  v_mfma_f32_16x16x32_bf16 v[20:23], v[56:59], v[240:243], v[20:23]
  v_mfma_f32_16x16x32_bf16 v[24:27], v[60:63], v[240:243], v[24:27]
  v_mfma_f32_16x16x32_bf16 v[36:39], v[60:63], v[244:247], v[36:39]
  s_waitcnt lgkmcnt(0)
  s_barrier
  v_mfma_f32_16x16x32_bf16 v[16:19], v[64:67], v[248:251], v[16:19]
  v_mfma_f32_16x16x32_bf16 v[28:31], v[64:67], v[252:255], v[28:31]
  v_mfma_f32_16x16x32_bf16 v[32:35], v[68:71], v[252:255], v[32:35]
  v_mfma_f32_16x16x32_bf16 v[20:23], v[68:71], v[248:251], v[20:23]
  v_mfma_f32_16x16x32_bf16 v[24:27], v[72:75], v[248:251], v[24:27]
  v_mfma_f32_16x16x32_bf16 v[36:39], v[72:75], v[252:255], v[36:39]
  s_setprio 0
  s_mov_b32 s31, 18
  s_cmp_lg_u32 s4, 3
  s_cbranch_scc1 L_nw0
  s_load_dword s31, s[40:41], s46
L_nw0:
  v_permlane16_swap_b32 v16, v28
  v_permlane16_swap_b32 v17, v29
  v_permlane16_swap_b32 v18, v30
  v_permlane16_swap_b32 v19, v31
  v_permlane16_swap_b32 v20, v32
  v_permlane16_swap_b32 v21, v33
  v_permlane16_swap_b32 v22, v34
  v_permlane16_swap_b32 v23, v35
  v_permlane16_swap_b32 v24, v36
  v_permlane16_swap_b32 v25, v37
  v_max3_f32 v96, v16, v17, v18
  v_min3_f32 v98, v16, v17, v18
  v_max3_f32 v96, v96, v19, v20
  v_min3_f32 v98, v98, v19, v20
  v_max3_f32 v96, v96, v21, v22
  v_min3_f32 v98, v98, v21, v22
  v_max3_f32 v96, v96, v23, v28
  v_min3_f32 v98, v98, v23, v28
  v_max3_f32 v96, v96, v29, v30
  v_min3_f32 v98, v98, v29, v30
  v_max3_f32 v96, v96, v31, v32
  v_min3_f32 v98, v98, v31, v32
  v_max3_f32 v96, v96, v33, v34
  v_min3_f32 v98, v98, v33, v34
  v_max3_f32 v96, v96, v35, v24
  v_min3_f32 v98, v98, v35, v24
  v_max_f32 v96, v96, v36
  v_min_f32 v98, v98, v36
  v_mul_f32 v96, 0xbfb8aa3b, v96
  v_mul_f32_e64 v98, s88, v98
  v_fmamk_f32 v40, v16, 0x3fb8aa3b, v96
  v_fmamk_f32 v58, v16, 0xbfb8aa3b, v98
  v_fmamk_f32 v41, v17, 0x3fb8aa3b, v96
  v_fmamk_f32 v59, v17, 0xbfb8aa3b, v98
  v_fmamk_f32 v42, v18, 0x3fb8aa3b, v96
  v_fmamk_f32 v60, v18, 0xbfb8aa3b, v98
  v_fmamk_f32 v43, v19, 0x3fb8aa3b, v96
  v_fmamk_f32 v61, v19, 0xbfb8aa3b, v98
  v_fmamk_f32 v44, v20, 0x3fb8aa3b, v96
  v_fmamk_f32 v62, v20, 0xbfb8aa3b, v98
  v_fmamk_f32 v45, v21, 0x3fb8aa3b, v96
  v_fmamk_f32 v63, v21, 0xbfb8aa3b, v98
  v_fmamk_f32 v46, v22, 0x3fb8aa3b, v96
  v_fmamk_f32 v64, v22, 0xbfb8aa3b, v98
  v_fmamk_f32 v47, v23, 0x3fb8aa3b, v96
  v_fmamk_f32 v65, v23, 0xbfb8aa3b, v98
  v_fmamk_f32 v48, v28, 0x3fb8aa3b, v96
  v_fmamk_f32 v66, v28, 0xbfb8aa3b, v98
  v_fmamk_f32 v49, v29, 0x3fb8aa3b, v96
  v_fmamk_f32 v67, v29, 0xbfb8aa3b, v98
  v_fmamk_f32 v50, v30, 0x3fb8aa3b, v96
  v_fmamk_f32 v68, v30, 0xbfb8aa3b, v98
  v_fmamk_f32 v51, v31, 0x3fb8aa3b, v96
  v_fmamk_f32 v69, v31, 0xbfb8aa3b, v98
  v_fmamk_f32 v52, v32, 0x3fb8aa3b, v96
  v_fmamk_f32 v70, v32, 0xbfb8aa3b, v98
  v_fmamk_f32 v53, v33, 0x3fb8aa3b, v96
  v_fmamk_f32 v71, v33, 0xbfb8aa3b, v98
  v_fmamk_f32 v54, v34, 0x3fb8aa3b, v96
  v_fmamk_f32 v72, v34, 0xbfb8aa3b, v98
  v_fmamk_f32 v55, v35, 0x3fb8aa3b, v96
  v_fmamk_f32 v73, v35, 0xbfb8aa3b, v98
  v_fmamk_f32 v56, v24, 0x3fb8aa3b, v96
  v_fmamk_f32 v74, v24, 0xbfb8aa3b, v98
  v_fmamk_f32 v57, v36, 0x3fb8aa3b, v96
L_pad19:
  v_fmamk_f32 v75, v36, 0xbfb8aa3b, v98
  v_exp_f32 v40, v40
  v_exp_f32 v41, v41
  v_exp_f32 v42, v42
  v_exp_f32 v43, v43
  v_exp_f32 v44, v44
  v_exp_f32 v45, v45
  v_exp_f32_e64 v46, v46
  ds_write_b128 v109, v[76:79] offset:0
  v_exp_f32 v47, v47
  v_exp_f32 v48, v48
  v_exp_f32 v49, v49
  v_exp_f32 v50, v50
  ds_write_b128 v109, v[80:83] offset:1024
  v_exp_f32 v51, v51
  v_exp_f32 v52, v52
  v_exp_f32 v53, v53
  v_exp_f32 v54, v54
  ds_write_b128 v109, v[84:87] offset:2048
  ds_read_u16 v6, v13 offset:2112
  v_exp_f32 v55, v55
  v_exp_f32 v56, v56
  v_exp_f32 v57, v57
  v_exp_f32 v58, v58
  v_exp_f32 v59, v59
  s_waitcnt lgkmcnt(0)
  s_cmp_lt_u32 s31, 18
  s_cbranch_scc0 L_nw1
  s_mov_b32 s87, 0
L_sl1:
  s_sleep 8
  s_load_dword s31, s[40:41], s46 glc
  s_add_u32 s87, s87, 1
  s_cmp_gt_u32 s87, 200000
  s_cbranch_scc1 L_se2
L_sc3:
  s_waitcnt lgkmcnt(0)
  s_cmp_lt_u32 s31, 18
  s_cbranch_scc1 L_sl1
L_se2:
  s_waitcnt lgkmcnt(0)
L_nw1:
  s_barrier
  v_exp_f32 v60, v60
  v_exp_f32 v61, v61
  v_exp_f32 v62, v62
  v_exp_f32 v63, v63
  v_exp_f32 v64, v64
  v_exp_f32 v65, v65
  v_exp_f32 v66, v66
  v_exp_f32 v67, v67
  v_exp_f32 v68, v68
  v_exp_f32 v69, v69
  v_exp_f32 v70, v70
  v_exp_f32 v71, v71
  v_exp_f32 v72, v72
  v_exp_f32 v73, v73
  v_exp_f32 v74, v74
  v_exp_f32 v75, v75
  v_add_f32 v98, v40, v42
  v_add_f32 v99, v41, v43
  v_add_f32 v96, v58, v60
  v_add_f32 v97, v59, v61
  v_add_f32 v98, v98, v44
  v_add_f32 v99, v99, v45
  v_add_f32 v96, v96, v62
  v_add_f32 v97, v97, v63
  v_add_f32 v98, v98, v46
  v_add_f32 v99, v99, v47
  v_add_f32 v96, v96, v64
  v_add_f32 v97, v97, v65
  v_add_f32 v98, v98, v48
  v_add_f32 v99, v99, v49
  v_add_f32 v96, v96, v66
  v_add_f32 v97, v97, v67
  v_add_f32 v98, v98, v50
  v_add_f32 v99, v99, v51
  v_add_f32 v96, v96, v68
  v_add_f32 v97, v97, v69
  v_add_f32 v98, v98, v52
  v_add_f32 v99, v99, v53
  v_add_f32 v96, v96, v70
  v_add_f32_e64 v97, v97, v71
  v_pk_add_f32 v[98:99], v[98:99], v[54:55]
  v_pk_add_f32 v[96:97], v[96:97], v[72:73]
  v_pk_add_f32 v[98:99], v[98:99], v[56:57]
  v_pk_add_f32 v[96:97], v[96:97], v[74:75]
  v_add_f32 v98, v98, v99
  v_add_f32 v96, v96, v97
  v_rcp_f32 v98, v98
  v_rcp_f32 v96, v96
  v_cvt_pk_bf16_f32 v94, v25, v37
  v_pk_mul_f32 v[40:41], v[40:41], v[98:99] op_sel_hi:[1,0]
  v_pk_mul_f32 v[42:43], v[42:43], v[98:99] op_sel_hi:[1,0]
  v_pk_mul_f32 v[44:45], v[44:45], v[98:99] op_sel_hi:[1,0]
  v_pk_mul_f32 v[46:47], v[46:47], v[98:99] op_sel_hi:[1,0]
  v_pk_mul_f32 v[48:49], v[48:49], v[98:99] op_sel_hi:[1,0]
  v_pk_mul_f32 v[50:51], v[50:51], v[98:99] op_sel_hi:[1,0]
  v_pk_mul_f32 v[52:53], v[52:53], v[98:99] op_sel_hi:[1,0]
  v_pk_mul_f32 v[54:55], v[54:55], v[98:99] op_sel_hi:[1,0]
  v_pk_mul_f32 v[56:57], v[56:57], v[98:99] op_sel_hi:[1,0]
  v_cvt_pk_bf16_f32 v76, v40, v41
  v_cvt_pk_bf16_f32 v77, v42, v43
  v_cvt_pk_bf16_f32 v78, v44, v45
  v_cvt_pk_bf16_f32 v79, v46, v47
  ds_write_b128 v12, v[76:79] offset:0
  v_cvt_pk_bf16_f32 v80, v48, v49
  v_cvt_pk_bf16_f32 v81, v50, v51
  v_cvt_pk_bf16_f32 v82, v52, v53
  v_cvt_pk_bf16_f32 v83, v54, v55
  ds_write_b128 v12, v[80:83] offset:16
  v_pk_mul_f32 v[58:59], v[58:59], v[96:97] op_sel_hi:[1,0]
  v_pk_mul_f32 v[60:61], v[60:61], v[96:97] op_sel_hi:[1,0]
  v_pk_mul_f32 v[62:63], v[62:63], v[96:97] op_sel_hi:[1,0]
  v_pk_mul_f32 v[64:65], v[64:65], v[96:97] op_sel_hi:[1,0]
  v_pk_mul_f32 v[66:67], v[66:67], v[96:97] op_sel_hi:[1,0]
  v_pk_mul_f32 v[68:69], v[68:69], v[96:97] op_sel_hi:[1,0]
  v_pk_mul_f32 v[70:71], v[70:71], v[96:97] op_sel_hi:[1,0]
  v_pk_mul_f32 v[72:73], v[72:73], v[96:97] op_sel_hi:[1,0]
  v_pk_mul_f32 v[74:75], v[74:75], v[96:97] op_sel_hi:[1,0]
  v_cvt_pk_bf16_f32 v84, v56, v57
  v_cvt_pk_bf16_f32 v85, v58, v59
  v_cvt_pk_bf16_f32 v86, v60, v61
  v_cvt_pk_bf16_f32 v87, v62, v63
  ds_write_b128 v12, v[84:87] offset:32
  v_cvt_pk_bf16_f32 v88, v64, v65
  v_cvt_pk_bf16_f32 v89, v66, v67
  v_cvt_pk_bf16_f32 v90, v68, v69
  v_cvt_pk_bf16_f32 v91, v70, v71
  ds_write_b128 v12, v[88:91] offset:48
  v_cvt_pk_bf16_f32 v92, v72, v73
  v_cvt_pk_bf16_f32 v93, v74, v75
  ds_write_b128 v12, v[92:95] offset:64
  s_waitcnt lgkmcnt(0)
  s_setprio 1
  s_barrier
  s_add_u32 m0, s84, 0
  s_add_u32 s3, s84, 0
  buffer_load_dwordx4 v3, s[24:27], s3 offen sc1 lds
  s_add_u32 m0, s84, 4096
  s_add_u32 s3, s84, 4096
  buffer_load_dwordx4 v3, s[24:27], s3 offen sc1 lds
  s_add_u32 m0, s84, 8192
  s_add_u32 s3, s84, 8192
  buffer_load_dwordx4 v3, s[24:27], s3 offen sc1 lds
  ds_read_b128 v[40:43], v10 offset:0
  ds_read_b128 v[44:47], v10 offset:1024
  ds_read_b128 v[48:51], v10 offset:2048
  ds_read_b128 v[52:55], v10 offset:3072
  s_waitcnt lgkmcnt(2)
  v_mfma_f32_16x16x32_bf16 v[16:19], v[40:43], v[112:115], 0
  ds_read_b128 v[56:59], v10 offset:4096
  v_mfma_f32_16x16x32_bf16 v[28:31], v[40:43], v[116:119], 0
  ds_read_b128 v[60:63], v10 offset:5120
  v_mfma_f32_16x16x32_bf16 v[32:35], v[44:47], v[116:119], 0
  v_lshlrev_b32 v102, 16, v6
  v_mul_f32 v102, s88, v102
  v_exp_f32_e64 v102, -v102
  v_mfma_f32_16x16x32_bf16 v[20:23], v[44:47], v[112:115], 0
  v_lshlrev_b32 v8, 2, v0
  v_add_f32 v102, 1.0, v102
  v_rcp_f32 v102, v102
  s_lshl_b32 s22, s83, 7
  s_add_u32 s22, s22, 7864320
  s_waitcnt lgkmcnt(2)
  v_mfma_f32_16x16x32_bf16 v[16:19], v[48:51], v[120:123], v[16:19]
  ds_read_b128 v[40:43], v10 offset:6144
  v_mfma_f32_16x16x32_bf16 v[28:31], v[48:51], v[124:127], v[28:31]
  ds_read_b128 v[44:47], v10 offset:7168
  v_mfma_f32_16x16x32_bf16 v[32:35], v[52:55], v[124:127], v[32:35]
  v_sub_f32_e64 v103, 1.0, v102
  s_mov_b32 exec_hi, 0
  s_cmp_lg_u32 s6, 0
  s_cbranch_scc1 L_nog
  buffer_store_dword v102, v8, s[40:43], s22 offen sc1
L_nog:
  s_mov_b64 exec, -1
  v_mfma_f32_16x16x32_bf16 v[20:23], v[52:55], v[120:123], v[20:23]
  s_waitcnt lgkmcnt(2)
L_pad20:
  s_cbranch_execz L_retack
  v_mfma_f32_16x16x32_bf16 v[16:19], v[56:59], v[128:131], v[16:19]
  ds_read_b128 v[48:51], v10 offset:8192
  v_mfma_f32_16x16x32_bf16 v[28:31], v[56:59], v[132:135], v[28:31]
  ds_read_b128 v[52:55], v10 offset:9216
  v_mfma_f32_16x16x32_bf16 v[32:35], v[60:63], v[132:135], v[32:35]
  v_mfma_f32_16x16x32_bf16 v[20:23], v[60:63], v[128:131], v[20:23]
  s_waitcnt lgkmcnt(2)
  v_mfma_f32_16x16x32_bf16 v[16:19], v[40:43], v[136:139], v[16:19]
  ds_read_b128 v[56:59], v10 offset:10240
  v_mfma_f32_16x16x32_bf16 v[28:31], v[40:43], v[140:143], v[28:31]
  ds_read_b128 v[60:63], v10 offset:11264
  v_mfma_f32_16x16x32_bf16 v[32:35], v[44:47], v[140:143], v[32:35]
  v_mfma_f32_16x16x32_bf16 v[20:23], v[44:47], v[136:139], v[20:23]
  s_waitcnt lgkmcnt(2)
  v_mfma_f32_16x16x32_bf16 v[16:19], v[48:51], v[144:147], v[16:19]
  ds_read_b128 v[40:43], v10 offset:12288
  v_mfma_f32_16x16x32_bf16 v[28:31], v[48:51], v[148:151], v[28:31]
  ds_read_b128 v[44:47], v10 offset:13312
  v_mfma_f32_16x16x32_bf16 v[32:35], v[52:55], v[148:151], v[32:35]
  v_mfma_f32_16x16x32_bf16 v[20:23], v[52:55], v[144:147], v[20:23]
  s_waitcnt lgkmcnt(2)
  v_mfma_f32_16x16x32_bf16 v[16:19], v[56:59], v[152:155], v[16:19]
  ds_read_b128 v[48:51], v10 offset:14336
  v_mfma_f32_16x16x32_bf16 v[28:31], v[56:59], v[156:159], v[28:31]
  ds_read_b128 v[52:55], v10 offset:15360
  v_mfma_f32_16x16x32_bf16 v[32:35], v[60:63], v[156:159], v[32:35]
  v_mfma_f32_16x16x32_bf16 v[20:23], v[60:63], v[152:155], v[20:23]
  s_waitcnt lgkmcnt(2)
  v_mfma_f32_16x16x32_bf16 v[16:19], v[40:43], v[160:163], v[16:19]
  ds_read_b128 v[56:59], v10 offset:16384
  v_mfma_f32_16x16x32_bf16 v[28:31], v[40:43], v[164:167], v[28:31]
  ds_read_b128 v[60:63], v10 offset:17408
  v_mfma_f32_16x16x32_bf16 v[32:35], v[44:47], v[164:167], v[32:35]
  v_and_b32 v4, 3, v0
  v_bfe_u32 v5, v0, 3, 2
  v_mfma_f32_16x16x32_bf16 v[20:23], v[44:47], v[160:163], v[20:23]
  v_lshl_add_u32 v4, v5, 2, v4
  v_lshrrev_b32 v5, 5, v0
  s_waitcnt lgkmcnt(2)
  v_mfma_f32_16x16x32_bf16 v[16:19], v[48:51], v[168:171], v[16:19]
  ds_read_b128 v[40:43], v10 offset:18432
  v_mfma_f32_16x16x32_bf16 v[28:31], v[48:51], v[172:175], v[28:31]
  ds_read_b128 v[44:47], v10 offset:19456
  v_mfma_f32_16x16x32_bf16 v[32:35], v[52:55], v[172:175], v[32:35]
  v_bfe_u32 v6, v0, 2, 1
  v_xor_b32_e64 v6, v6, v5
  v_mfma_f32_16x16x32_bf16 v[20:23], v[52:55], v[168:171], v[20:23]
  v_mul_u32_u24 v5, 1440, v5
  v_lshl_add_u32 v5, v6, 18, v5
  s_waitcnt lgkmcnt(2)
  v_mfma_f32_16x16x32_bf16 v[16:19], v[56:59], v[176:179], v[16:19]
  s_barrier
  ds_read_b128 v[48:51], v10 offset:20480
  v_mfma_f32_16x16x32_bf16 v[28:31], v[56:59], v[180:183], v[28:31]
  ds_read_b128 v[52:55], v10 offset:21504
  v_mfma_f32_16x16x32_bf16 v[32:35], v[60:63], v[180:183], v[32:35]
  v_add_u32 v5, 157696, v5
  v_lshl_add_u32 v110, v4, 4, v5
  v_mfma_f32_16x16x32_bf16 v[20:23], v[60:63], v[176:179], v[20:23]
  v_lshl_add_u32 v111, v4, 3, v5
  v_lshrrev_b32 v4, 2, v4
  s_waitcnt lgkmcnt(2)
  v_mfma_f32_16x16x32_bf16 v[16:19], v[40:43], v[184:187], v[16:19]
  ds_read_b128 v[56:59], v10 offset:22528
  v_mfma_f32_16x16x32_bf16 v[28:31], v[40:43], v[188:191], v[28:31]
  ds_read_b128 v[60:63], v10 offset:23552
  v_mfma_f32_16x16x32_bf16 v[32:35], v[44:47], v[188:191], v[32:35]
  v_min_u32 v4, 1, v4
  v_lshlrev_b32 v4, 18, v4
  v_mfma_f32_16x16x32_bf16 v[20:23], v[44:47], v[184:187], v[20:23]
  v_or_b32 v108, v110, v4
  v_or_b32_e64 v109, v111, v4
  s_waitcnt lgkmcnt(2)
  v_mfma_f32_16x16x32_bf16 v[16:19], v[48:51], v[192:195], v[16:19]
  ds_read_b128 v[40:43], v10 offset:24576
  v_mfma_f32_16x16x32_bf16 v[28:31], v[48:51], v[196:199], v[28:31]
  ds_read_b128 v[44:47], v10 offset:25600
  v_mfma_f32_16x16x32_bf16 v[32:35], v[52:55], v[196:199], v[32:35]
  v_and_b32_e64 v4, 1, v2
  v_mul_u32_u24 v4, 18432, v4
  v_mfma_f32_16x16x32_bf16 v[20:23], v[52:55], v[192:195], v[20:23]
  v_lshl_add_u32 v14, v1, 3, v4
  v_lshl_add_u32 v4, v1, 4, v4
  s_waitcnt lgkmcnt(2)
  v_mfma_f32_16x16x32_bf16 v[16:19], v[56:59], v[200:203], v[16:19]
  ds_read_b128 v[48:51], v10 offset:26624
  v_mfma_f32_16x16x32_bf16 v[28:31], v[56:59], v[204:207], v[28:31]
  ds_read_b128 v[52:55], v10 offset:27648
  v_mfma_f32_16x16x32_bf16 v[32:35], v[60:63], v[204:207], v[32:35]
  v_lshrrev_b32 v5, 5, v0
  v_lshl_add_u32 v13, v5, 9, v4
  v_mfma_f32_16x16x32_bf16 v[20:23], v[60:63], v[200:203], v[20:23]
  s_mul_i32 s91, s83, 36864
  s_add_u32 s91, s91, 5505024
  s_waitcnt lgkmcnt(2)
  v_mfma_f32_16x16x32_bf16 v[16:19], v[40:43], v[208:211], v[16:19]
  ds_read_b128 v[56:59], v10 offset:28672
  v_mfma_f32_16x16x32_bf16 v[28:31], v[40:43], v[212:215], v[28:31]
  ds_read_b128 v[60:63], v10 offset:29696
  v_mfma_f32_16x16x32_bf16 v[32:35], v[44:47], v[212:215], v[32:35]
  s_lshl_b32 s45, s6, 7
  s_add_u32 s92, s91, s45
  v_mfma_f32_16x16x32_bf16 v[20:23], v[44:47], v[208:211], v[20:23]
  s_add_u32 s92, s92, 16384
  s_lshl_b32 s45, s6, 10
  s_waitcnt lgkmcnt(2)
  v_mfma_f32_16x16x32_bf16 v[16:19], v[48:51], v[216:219], v[16:19]
  s_barrier
  ds_read_b128 v[40:43], v10 offset:30720
  v_mfma_f32_16x16x32_bf16 v[28:31], v[48:51], v[220:223], v[28:31]
  ds_read_b128 v[44:47], v10 offset:31744
  v_mfma_f32_16x16x32_bf16 v[32:35], v[52:55], v[220:223], v[32:35]
  s_add_u32 s91, s91, s45
  s_and_b32 s45, s83, 31
  v_mfma_f32_16x16x32_bf16 v[20:23], v[52:55], v[216:219], v[20:23]
  s_mul_i32 s45, s45, 2304
  s_add_u32 s45, s45, 7929864
  s_waitcnt lgkmcnt(2)
  v_mfma_f32_16x16x32_bf16 v[16:19], v[56:59], v[224:227], v[16:19]
  ds_read_b128 v[48:51], v10 offset:32768
  v_mfma_f32_16x16x32_bf16 v[28:31], v[56:59], v[228:231], v[28:31]
  ds_read_b128 v[52:55], v10 offset:33792
  v_mfma_f32_16x16x32_bf16 v[32:35], v[60:63], v[228:231], v[32:35]
  s_add_u32 s28, s40, s45
  s_addc_u32 s29, s41, 0
  v_mfma_f32_16x16x32_bf16 v[20:23], v[60:63], v[224:227], v[20:23]
  s_mov_b32 s1, 1
  s_waitcnt lgkmcnt(2)
  v_mfma_f32_16x16x32_bf16 v[16:19], v[40:43], v[232:235], v[16:19]
  ds_read_b128 v[56:59], v10 offset:34816
  v_mfma_f32_16x16x32_bf16 v[28:31], v[40:43], v[236:239], v[28:31]
  ds_read_b128 v[60:63], v10 offset:35840
  v_mfma_f32_16x16x32_bf16 v[32:35], v[44:47], v[236:239], v[32:35]
  v_mfma_f32_16x16x32_bf16 v[20:23], v[44:47], v[232:235], v[20:23]
  s_waitcnt lgkmcnt(2)
  v_mfma_f32_16x16x32_bf16 v[16:19], v[48:51], v[240:243], v[16:19]
  v_mfma_f32_16x16x32_bf16 v[28:31], v[48:51], v[244:247], v[28:31]
  v_mfma_f32_16x16x32_bf16 v[32:35], v[52:55], v[244:247], v[32:35]
  v_mfma_f32_16x16x32_bf16 v[20:23], v[52:55], v[240:243], v[20:23]
  s_waitcnt lgkmcnt(0)
  v_mfma_f32_16x16x32_bf16 v[16:19], v[56:59], v[248:251], v[16:19]
  v_mfma_f32_16x16x32_bf16 v[28:31], v[56:59], v[252:255], v[28:31]
  v_mfma_f32_16x16x32_bf16 v[32:35], v[60:63], v[252:255], v[32:35]
  v_mfma_f32_16x16x32_bf16 v[20:23], v[60:63], v[248:251], v[20:23]
L_pad21:
  s_nop 5
  v_permlane16_swap_b32 v16, v28
  v_permlane16_swap_b32 v17, v29
  v_permlane16_swap_b32 v18, v30
  v_permlane16_swap_b32 v19, v31
  v_permlane16_swap_b32 v20, v32
  v_permlane16_swap_b32 v21, v33
  v_permlane16_swap_b32 v22, v34
  v_permlane16_swap_b32 v23, v35
  v_permlane16_swap_b32 v26, v38
  v_max3_f32 v96, v16, v17, v18
  v_min3_f32 v98, v16, v17, v18
  v_max3_f32 v96, v96, v19, v20
  v_min3_f32 v98, v98, v19, v20
  v_max3_f32 v96, v96, v21, v22
  v_min3_f32 v98, v98, v21, v22
  v_max3_f32 v96, v96, v23, v28
  v_min3_f32 v98, v98, v23, v28
  v_max3_f32 v96, v96, v29, v30
  v_min3_f32 v98, v98, v29, v30
  v_max3_f32 v96, v96, v31, v32
  v_min3_f32 v98, v98, v31, v32
  v_max3_f32 v96, v96, v33, v34
  v_min3_f32 v98, v98, v33, v34
  v_max3_f32 v96, v96, v35, v26
  v_min3_f32 v98, v98, v35, v26
  v_max_f32 v96, v96, v38
  v_min_f32 v98, v98, v38
  v_mul_f32 v96, s88, v96
  v_mul_f32_e64 v98, s88, v98
  v_pk_fma_f32 v[40:41], v[16:17], s[88:89], v[96:97] op_sel_hi:[1,1,0] neg_lo:[0,0,1] neg_hi:[0,0,1]
  v_pk_fma_f32 v[58:59], v[16:17], s[88:89], v[98:99] op_sel_hi:[1,1,0] neg_lo:[1,0,0] neg_hi:[1,0,0]
  v_pk_fma_f32 v[42:43], v[18:19], s[88:89], v[96:97] op_sel_hi:[1,1,0] neg_lo:[0,0,1] neg_hi:[0,0,1]
  v_pk_fma_f32 v[60:61], v[18:19], s[88:89], v[98:99] op_sel_hi:[1,1,0] neg_lo:[1,0,0] neg_hi:[1,0,0]
  v_pk_fma_f32 v[44:45], v[20:21], s[88:89], v[96:97] op_sel_hi:[1,1,0] neg_lo:[0,0,1] neg_hi:[0,0,1]
  v_pk_fma_f32 v[62:63], v[20:21], s[88:89], v[98:99] op_sel_hi:[1,1,0] neg_lo:[1,0,0] neg_hi:[1,0,0]
  v_pk_fma_f32 v[46:47], v[22:23], s[88:89], v[96:97] op_sel_hi:[1,1,0] neg_lo:[0,0,1] neg_hi:[0,0,1]
  v_pk_fma_f32 v[64:65], v[22:23], s[88:89], v[98:99] op_sel_hi:[1,1,0] neg_lo:[1,0,0] neg_hi:[1,0,0]
  v_pk_fma_f32 v[48:49], v[28:29], s[88:89], v[96:97] op_sel_hi:[1,1,0] neg_lo:[0,0,1] neg_hi:[0,0,1]
  v_pk_fma_f32 v[66:67], v[28:29], s[88:89], v[98:99] op_sel_hi:[1,1,0] neg_lo:[1,0,0] neg_hi:[1,0,0]
  v_pk_fma_f32 v[50:51], v[30:31], s[88:89], v[96:97] op_sel_hi:[1,1,0] neg_lo:[0,0,1] neg_hi:[0,0,1]
  v_pk_fma_f32 v[68:69], v[30:31], s[88:89], v[98:99] op_sel_hi:[1,1,0] neg_lo:[1,0,0] neg_hi:[1,0,0]
  v_pk_fma_f32 v[52:53], v[32:33], s[88:89], v[96:97] op_sel_hi:[1,1,0] neg_lo:[0,0,1] neg_hi:[0,0,1]
  v_pk_fma_f32 v[70:71], v[32:33], s[88:89], v[98:99] op_sel_hi:[1,1,0] neg_lo:[1,0,0] neg_hi:[1,0,0]
  v_pk_fma_f32 v[54:55], v[34:35], s[88:89], v[96:97] op_sel_hi:[1,1,0] neg_lo:[0,0,1] neg_hi:[0,0,1]
  v_pk_fma_f32 v[72:73], v[34:35], s[88:89], v[98:99] op_sel_hi:[1,1,0] neg_lo:[1,0,0] neg_hi:[1,0,0]
  v_fma_f32 v56, v26, s88, -v96
  v_fma_f32 v74, -v26, s88, v98
  v_fma_f32 v57, v38, s88, -v96
  v_fma_f32 v75, -v38, s88, v98
  v_exp_f32 v40, v40
  v_exp_f32 v41, v41
  v_exp_f32 v42, v42
  v_exp_f32 v43, v43
  v_exp_f32 v44, v44
  v_exp_f32 v45, v45
  v_exp_f32 v46, v46
  v_exp_f32 v47, v47
  v_exp_f32 v48, v48
  v_exp_f32 v49, v49
  v_exp_f32 v50, v50
  v_exp_f32 v51, v51
  v_exp_f32 v52, v52
  v_exp_f32 v53, v53
  v_exp_f32 v54, v54
  v_exp_f32 v55, v55
  v_exp_f32 v56, v56
  v_exp_f32 v57, v57
  v_exp_f32 v58, v58
  v_exp_f32 v59, v59
  v_exp_f32 v60, v60
  v_exp_f32 v61, v61
  v_exp_f32 v62, v62
  v_exp_f32 v63, v63
  v_exp_f32 v64, v64
  v_exp_f32 v65, v65
  v_exp_f32 v66, v66
  v_exp_f32 v67, v67
  v_exp_f32 v68, v68
  v_exp_f32 v69, v69
  v_exp_f32 v70, v70
  v_exp_f32 v71, v71
  v_exp_f32 v72, v72
  v_exp_f32 v73, v73
  v_exp_f32 v74, v74
  v_exp_f32 v75, v75
  v_pk_add_f32 v[98:99], v[40:41], v[42:43]
  v_pk_add_f32 v[96:97], v[58:59], v[60:61]
  v_pk_add_f32 v[98:99], v[98:99], v[44:45]
  v_pk_add_f32 v[96:97], v[96:97], v[62:63]
  v_pk_add_f32 v[98:99], v[98:99], v[46:47]
  v_pk_add_f32 v[96:97], v[96:97], v[64:65]
  v_pk_add_f32 v[98:99], v[98:99], v[48:49]
  v_pk_add_f32 v[96:97], v[96:97], v[66:67]
  v_pk_add_f32 v[98:99], v[98:99], v[50:51]
  v_pk_add_f32 v[96:97], v[96:97], v[68:69]
  v_pk_add_f32 v[98:99], v[98:99], v[52:53]
  v_pk_add_f32 v[96:97], v[96:97], v[70:71]
  v_pk_add_f32 v[98:99], v[98:99], v[54:55]
  v_pk_add_f32 v[96:97], v[96:97], v[72:73]
  v_pk_add_f32 v[98:99], v[98:99], v[56:57]
  v_pk_add_f32 v[96:97], v[96:97], v[74:75]
  v_add_f32 v98, v98, v99
  v_add_f32 v96, v96, v97
  v_rcp_f32_e64 v96, v96
  v_cvt_pk_bf16_f32 v76, v40, v41
  v_cvt_pk_bf16_f32 v77, v42, v43
  v_cvt_pk_bf16_f32 v80, v44, v45
  v_cvt_pk_bf16_f32 v81, v46, v47
  v_cvt_pk_bf16_f32 v84, v48, v49
  v_cvt_pk_bf16_f32 v85, v50, v51
  v_cvt_pk_bf16_f32 v88, v52, v53
  v_cvt_pk_bf16_f32 v89, v54, v55
  v_cvt_pk_bf16_f32 v78, v56, v57
  v_mul_f32_e64 v96, v96, v98
  v_mul_f32 v98, 0x358637bd, v98
  v_pk_mul_f32 v[58:59], v[58:59], v[96:97] op_sel_hi:[1,0]
  v_pk_mul_f32 v[60:61], v[60:61], v[96:97] op_sel_hi:[1,0]
  v_pk_mul_f32 v[62:63], v[62:63], v[96:97] op_sel_hi:[1,0]
  v_pk_mul_f32 v[64:65], v[64:65], v[96:97] op_sel_hi:[1,0]
  v_pk_mul_f32 v[66:67], v[66:67], v[96:97] op_sel_hi:[1,0]
  v_pk_mul_f32 v[68:69], v[68:69], v[96:97] op_sel_hi:[1,0]
  v_pk_mul_f32 v[70:71], v[70:71], v[96:97] op_sel_hi:[1,0]
  v_pk_mul_f32 v[72:73], v[72:73], v[96:97] op_sel_hi:[1,0]
  v_pk_mul_f32 v[74:75], v[74:75], v[96:97] op_sel_hi:[1,0]
  v_cvt_pk_bf16_f32 v79, v58, v59
  v_cvt_pk_bf16_f32 v82, v60, v61
  v_cvt_pk_bf16_f32 v83, v62, v63
  v_cvt_pk_bf16_f32 v86, v64, v65
  v_cvt_pk_bf16_f32 v87, v66, v67
  v_cvt_pk_bf16_f32 v90, v68, v69
  v_cvt_pk_bf16_f32 v91, v70, v71
  v_cvt_pk_bf16_f32 v92, v72, v73
  v_cvt_pk_bf16_f32 v93, v74, v75
M_smq:
  s_setprio 2
  s_waitcnt vmcnt(0)
  s_barrier
  ds_read_b128 v[130:133], v108 offset:256
  ds_read_b128 v[134:137], v108 offset:576
  ds_read_b128 v[138:141], v108 offset:896
  ds_read_b128 v[142:145], v108 offset:1216
  ds_read_b64 v[146:147], v109 offset:1408
  ds_read_b128 v[112:115], v110 offset:0
  ds_read_b128 v[116:119], v110 offset:320
  ds_read_b128 v[120:123], v110 offset:640
  ds_read_b128 v[124:127], v110 offset:960
  ds_read_b64 v[128:129], v111 offset:1280
  s_waitcnt lgkmcnt(9)
  v_mfma_f32_32x32x16_bf16 v[32:47], v[130:133], v[76:79], 0
  s_waitcnt lgkmcnt(8)
  v_mfma_f32_32x32x16_bf16 v[32:47], v[134:137], v[80:83], v[32:47]
  s_waitcnt lgkmcnt(7)
  v_mfma_f32_32x32x16_bf16 v[32:47], v[138:141], v[84:87], v[32:47]
  s_waitcnt lgkmcnt(6)
  v_mfma_f32_32x32x16_bf16 v[32:47], v[142:145], v[88:91], v[32:47]
  s_waitcnt lgkmcnt(5)
  v_mfma_f32_32x32x8_bf16 v[32:47], v[146:147], v[92:93], v[32:47]
L_pad22:
  s_waitcnt lgkmcnt(4)
  v_mfma_f32_32x32x16_bf16 v[16:31], v[112:115], v[76:79], 0
  s_waitcnt lgkmcnt(3)
  v_mfma_f32_32x32x16_bf16 v[16:31], v[116:119], v[80:83], v[16:31]
  s_waitcnt lgkmcnt(2)
  v_mfma_f32_32x32x16_bf16 v[16:31], v[120:123], v[84:87], v[16:31]
  s_waitcnt lgkmcnt(1)
  v_mfma_f32_32x32x16_bf16 v[16:31], v[124:127], v[88:91], v[16:31]
  s_waitcnt lgkmcnt(0)
  v_mfma_f32_32x32x8_bf16 v[16:31], v[128:129], v[92:93], v[16:31]
  s_nop 1
  v_add_f32 v98, v98, v34
  v_rcp_f32 v98, v98
  s_nop 0
  v_mul_f32 v98, v98, v103
  v_mul_f32 v32, v98, v32
  v_mul_f32 v33, v98, v33
  v_cvt_pk_bf16_f32 v32, v32, v33
  v_mov_b32 v33, v32
  s_nop 1
  v_pk_mul_f32 v[16:17], v[16:17], v[98:99] op_sel_hi:[1,0]
  v_pk_mul_f32 v[18:19], v[18:19], v[98:99] op_sel_hi:[1,0]
  v_pk_mul_f32 v[20:21], v[20:21], v[98:99] op_sel_hi:[1,0]
  v_pk_mul_f32 v[22:23], v[22:23], v[98:99] op_sel_hi:[1,0]
  v_cvt_pk_bf16_f32 v48, v16, v17
  v_cvt_pk_bf16_f32 v49, v18, v19
  v_cvt_pk_bf16_f32 v50, v20, v21
  v_cvt_pk_bf16_f32 v51, v22, v23
  buffer_store_dwordx4 v[48:51], v13, s[40:43], s91 offen offset:0 sc1
  v_pk_mul_f32 v[24:25], v[24:25], v[98:99] op_sel_hi:[1,0]
  v_pk_mul_f32 v[26:27], v[26:27], v[98:99] op_sel_hi:[1,0]
  v_pk_mul_f32 v[28:29], v[28:29], v[98:99] op_sel_hi:[1,0]
  v_pk_mul_f32 v[30:31], v[30:31], v[98:99] op_sel_hi:[1,0]
  v_cvt_pk_bf16_f32 v52, v24, v25
  v_cvt_pk_bf16_f32 v53, v26, v27
  v_cvt_pk_bf16_f32 v54, v28, v29
  v_cvt_pk_bf16_f32 v55, v30, v31
  buffer_store_dwordx4 v[52:55], v13, s[40:43], s91 offen offset:256 sc1
  v_permlane32_swap_b32 v32, v33
  s_mov_b32 exec_lo, 0xffffffff
  s_mov_b32 exec_hi, 0x0
  buffer_store_dwordx2 v[32:33], v14, s[40:43], s92 offen sc1
  s_atomic_add s1, s[28:29], 0
  s_atomic_add s1, s[28:29], 1152
  s_mov_b64 exec, -1
  s_endpgm
.section .rodata,"a"
.p2align 6
.amdhsa_kernel gated_mix__spectral_fnet__linear_kernel_hedgehog__prompt_kernel
  .amdhsa_next_free_vgpr 256
  .amdhsa_next_free_sgpr 102
  .amdhsa_accum_offset 256
  .amdhsa_group_segment_fixed_size 0
  .amdhsa_kernarg_size 104
  .amdhsa_user_sgpr_count 2
  .amdhsa_user_sgpr_kernarg_segment_ptr 1
  .amdhsa_system_sgpr_workgroup_id_x 1
.end_amdhsa_kernel
```
